```python
import torch

def _softmax(x, axis=-1):
    return torch.softmax(x, dim=axis)
def _gelu(x):
    return torch.nn.functional.gelu(x, approximate="tanh")
def _silu(x):
    return torch.nn.functional.silu(x)
def _sigmoid(x):
    return torch.sigmoid(x)
def _layernorm(x, axis=-1, eps=1e-5):
    m = x.mean(dim=axis, keepdim=True)
    v = x.var(dim=axis, keepdim=True, unbiased=False)
    return (x - m) / torch.sqrt(v + eps)
def _scatter_add(tgt, idx, src, axis=0):
    return tgt.clone().index_add_(axis, idx, src)
def _segment_sum(src, seg, n):
    out = torch.zeros((n,) + src.shape[1:], dtype=src.dtype)
    return out.index_add_(0, seg, src)
def _pad(x, pw):
    flat = tuple(v for pair in reversed(pw) for v in pair)
    return torch.nn.functional.pad(x, flat)

kernel_name = 'concat_heads__gqa_block_cached__gqa_block_cached__decode'

def setup_inputs():

    _w = (lambda a: (lambda t: t.to(torch.bfloat16) if t.is_floating_point() else t)(torch.as_tensor(a)))
    def _A_setup():
        B, Sq, D = 2, 1, 1024
        Hq, Hkv, Sk, Dh = 32, 4, 32768, 128
        assert Hq % Hkv == 0, (Hq, Hkv)
        return {
            "x": _w((lambda *s: torch.randn(*s, dtype=torch.bfloat16) * 0.8)(B, Sq, D)),
            "k_cache": _w((lambda *s: torch.randn(*s, dtype=torch.bfloat16) * 0.8)(B, Hkv, Sk, Dh)),
            "v_cache": _w((lambda *s: torch.randn(*s, dtype=torch.bfloat16) * 0.05)(B, Hkv, Sk, Dh)),
            "wq": _w((lambda *s: torch.randn(*s, dtype=torch.bfloat16) * 0.8)(D, Hq * Dh) * (D ** -0.5)),
            "wo": _w((lambda *s: torch.randn(*s, dtype=torch.bfloat16) * 0.05)(Hq * Dh, D) * ((Hq * Dh) ** -0.5)),
        }
    _A_in = _A_setup()

    def _B_setup():
        B, Sq, D = 2, 1, 1024
        Hq, Hkv, Sk, Dh = 32, 4, 32768, 128
        assert Hq % Hkv == 0, (Hq, Hkv)
        return {
            "x": _w((lambda *s: torch.randn(*s, dtype=torch.bfloat16) * 0.8)(B, Sq, D)),
            "k_cache": _w((lambda *s: torch.randn(*s, dtype=torch.bfloat16) * 0.8)(B, Hkv, Sk, Dh)),
            "v_cache": _w((lambda *s: torch.randn(*s, dtype=torch.bfloat16) * 0.05)(B, Hkv, Sk, Dh)),
            "wq": _w((lambda *s: torch.randn(*s, dtype=torch.bfloat16) * 0.8)(D, Hq * Dh) * (D ** -0.5)),
            "wo": _w((lambda *s: torch.randn(*s, dtype=torch.bfloat16) * 0.05)(Hq * Dh, D) * ((Hq * Dh) ** -0.5)),
        }
    _B_in = _B_setup()

    return {
        "A_x": _A_in["x"],
        "A_k_cache": _A_in["k_cache"],
        "A_v_cache": _A_in["v_cache"],
        "A_wq": _A_in["wq"],
        "A_wo": _A_in["wo"],
        "B_x": _B_in["x"],
        "B_k_cache": _B_in["k_cache"],
        "B_v_cache": _B_in["v_cache"],
        "B_wq": _B_in["wq"],
        "B_wo": _B_in["wo"],
    }

def reference(A_x, A_k_cache, A_v_cache, A_wq, A_wo, B_x, B_k_cache, B_v_cache, B_wq, B_wo):
    def _A_ref(x, k_cache, v_cache, wq, wo):
        B, Sq, D = x.shape
        Hq, Dh = 32, 128
        Hkv = k_cache.shape[1]
        rep = Hq // Hkv
        q = (lambda x, *d: x.permute(*d))((x @ wq).reshape(B, Sq, Hq, Dh), 0, 2, 1, 3)
        k = (lambda x, n, axis: torch.repeat_interleave(x, n, dim=axis))(k_cache, rep, axis=1)
        v = (lambda x, n, axis: torch.repeat_interleave(x, n, dim=axis))(v_cache, rep, axis=1)
        scores = torch.einsum("bhqd,bhkd->bhqk", q, k) * (Dh ** -0.5)
        p = _softmax(scores, axis=-1)
        o = torch.einsum("bhqk,bhkd->bhqd", p, v)
        return (lambda x, *d: x.permute(*d))(o, 0, 2, 1, 3).reshape(B, Sq, Hq * Dh) @ wo

    def _B_ref(x, k_cache, v_cache, wq, wo):
        B, Sq, D = x.shape
        Hq, Dh = 32, 128
        Hkv = k_cache.shape[1]
        rep = Hq // Hkv
        q = (lambda x, *d: x.permute(*d))((x @ wq).reshape(B, Sq, Hq, Dh), 0, 2, 1, 3)
        k = (lambda x, n, axis: torch.repeat_interleave(x, n, dim=axis))(k_cache, rep, axis=1)
        v = (lambda x, n, axis: torch.repeat_interleave(x, n, dim=axis))(v_cache, rep, axis=1)
        scores = torch.einsum("bhqd,bhkd->bhqk", q, k) * (Dh ** -0.5)
        p = _softmax(scores, axis=-1)
        o = torch.einsum("bhqk,bhkd->bhqd", p, v)
        return (lambda x, *d: x.permute(*d))(o, 0, 2, 1, 3).reshape(B, Sq, Hq * Dh) @ wo

    a = _A_ref(A_x, A_k_cache, A_v_cache, A_wq, A_wo)
    b = _B_ref(B_x, B_k_cache, B_v_cache, B_wq, B_wo)
    return torch.concatenate([a, b], axis=-1)
```

```asm
; @launch grid=(256,1,1) block=(256,1,1) lds=45056
.amdgcn_target "amdgcn-amd-amdhsa--gfx950"
.text
.globl concat_heads__gqa_block_cached__gqa_block_cached__decode_kernel
.p2align 8
.type concat_heads__gqa_block_cached__gqa_block_cached__decode_kernel,@function
concat_heads__gqa_block_cached__gqa_block_cached__decode_kernel:
    s_cmp_ge_u32 s2, 0x100
    s_cbranch_scc1 L_end
    s_lshr_b32 s3, s2, 7
    s_mul_i32 s4, s3, 40
    s_add_u32 s5, s4, 24
    s_load_dwordx4 s[16:19], s[0:1], s5
    s_load_dwordx2 s[6:7], s[0:1], s4
    s_load_dwordx4 s[8:11], s[0:1], 8
    s_load_dwordx4 s[12:15], s[0:1], 48
    s_load_dwordx4 s[20:23], s[0:1], 80
    s_load_dwordx2 s[24:25], s[0:1], 96
    v_and_b32 v1, 63, v0
    v_lshrrev_b32 v6, 6, v0
    v_lshrrev_b32 v7, 4, v1
    v_readfirstlane_b32 s26, v6
    s_bfe_u32 s59, s2, 0x20005
    s_lshr_b32 s27, s2, 5
    s_lshl_b32 s27, s27, 2
    s_add_u32 s27, s27, s2
    s_and_b32 s27, s27, 31
    v_lshlrev_b32 v4, 19, v6
    v_lshl_or_b32 v4, v7, 16, v4
    v_and_b32 v9, 15, v1
    v_lshl_or_b32 v4, v9, 4, v4
    v_lshlrev_b32 v5, 7, v6
    v_lshl_or_b32 v5, v7, 4, v5
    v_and_b32 v10, 1, v1
    v_lshl_or_b32 v5, v10, 11, v5
    s_lshl_b32 s4, s59, 11
    s_lshr_b32 s5, s27, 2
    s_lshl_b32 s5, s5, 8
    s_add_u32 s4, s4, s5
    s_and_b32 s63, s27, 3
    s_lshl_b32 s5, s63, 21
    s_add_u32 s4, s4, s5
    s_lshl_b32 s63, s63, 9
    s_mov_b32 s38, 2089216
    s_mov_b32 s39, 0x20000
    s_mov_b32 s46, 4096
    s_mov_b32 s47, 0x20000
    s_mov_b32 s58, 0
    s_waitcnt lgkmcnt(0)
    s_add_u32 s36, s16, s4
    s_addc_u32 s37, s17, 0
    s_mov_b32 s44, s6
    s_mov_b32 s45, s7
    buffer_load_dwordx4 v[128:131], v4, s[36:39], s58 offen nt
    s_addk_i32 s58, 0x2000
    buffer_load_dwordx4 v[132:135], v4, s[36:39], s58 offen nt
    s_addk_i32 s58, 0x2000
    buffer_load_dwordx4 v[136:139], v4, s[36:39], s58 offen nt
    s_addk_i32 s58, 0x2000
    buffer_load_dwordx4 v[56:59], v5, s[44:47], s63 offen
    buffer_load_dwordx4 v[60:63], v5, s[44:47], s63 offen offset:64
    s_lshl_b32 s4, s2, 18
    s_add_u32 s28, s8, s4
    s_addc_u32 s29, s9, 0
    s_mov_b32 s30, 0x40000
    s_mov_b32 s31, 0x20000
    s_add_u32 s32, s10, s4
    s_addc_u32 s33, s11, 0
    s_mov_b32 s34, 0x40000
    s_mov_b32 s35, 0x20000
    s_add_u32 s44, s14, s4
    s_addc_u32 s45, s15, 0
    s_mov_b32 s46, 0x40000
    s_mov_b32 s47, 0x20000
    s_mov_b32 s48, s24
    s_mov_b32 s49, s25
    s_mov_b32 s50, 5242880
    s_mov_b32 s51, 0x20000
    s_lshl_b32 s4, s59, 21
    s_lshr_b32 s5, s27, 1
    s_lshl_b32 s5, s5, 17
    s_add_u32 s4, s4, s5
    s_and_b32 s5, s27, 1
    s_lshl_b32 s5, s5, 10
    s_add_u32 s4, s4, s5
    s_add_u32 s40, s18, s4
    s_addc_u32 s41, s19, 0
    s_mov_b32 s42, 130048
    s_mov_b32 s43, 0x20000
    s_lshl_b32 s56, s26, 12
    s_mov_b32 s57, s56
    v_bfe_u32 v2, v1, 1, 1
    v_lshlrev_b32 v2, 10, v2
    v_bfe_u32 v8, v1, 2, 2
    v_lshl_or_b32 v2, v8, 8, v2
    v_lshl_or_b32 v2, v7, 5, v2
    v_lshl_or_b32 v2, v10, 4, v2
    v_lshlrev_b32 v3, 4, v1
    s_mov_b32 s60, 0x05040100
    s_mov_b32 s61, 0x07060302
    s_mov_b32 s62, 0x3e0293ee
    s_lshl_b32 s73, s2, 12
    s_add_u32 s73, s73, 2097152
    s_add_u32 s75, s73, 0x100000
    s_and_b32 s74, s27, 1
    s_lshl_b32 s4, s3, 1
    s_add_u32 s74, s74, s4
    s_lshl_b32 s74, s74, 2
    s_add_u32 s74, s74, s59
    s_lshl_b32 s74, s74, 4
    s_lshr_b32 s4, s27, 1
    s_add_u32 s74, s74, s4
    s_lshl_b32 s74, s74, 12
    s_add_u32 s74, s74, 4194304
    s_lshl_b32 s76, s2, 7
    s_add_u32 s76, s76, 262144
    s_lshl_b32 s19, s3, 7
    s_lshl_b32 s18, s59, 2
    s_add_u32 s19, s19, s18
    s_mov_b32 s18, 1
    s_mov_b32 s68, 0x4000
    s_mov_b32 s69, 0x8000
    s_mov_b32 s70, 0xc000
    v_mul_u32_u24 v12, 1152, v6
    v_lshl_add_u32 v12, v7, 5, v12
    v_lshl_add_u32 v12, v10, 4, v12
    buffer_load_dwordx4 a[0:3], v2, s[28:31], s56 offen offset:0 nt
    buffer_load_dwordx4 v[140:143], v4, s[36:39], s58 offen nt
    s_addk_i32 s58, 0x2000
    buffer_load_dwordx4 a[4:7], v2, s[28:31], s56 offen offset:128 nt
    s_waitcnt vmcnt(7)
    buffer_load_dwordx4 v[144:147], v4, s[36:39], s58 offen nt
    s_addk_i32 s58, 0x2000
    s_waitcnt vmcnt(7)
    buffer_load_dwordx4 a[8:11], v2, s[28:31], s56 offen offset:2048 nt
    s_waitcnt vmcnt(7)
    buffer_load_dwordx4 v[148:151], v4, s[36:39], s58 offen nt
    s_addk_i32 s58, 0x2000
    s_waitcnt vmcnt(5)
    buffer_load_dwordx4 a[12:15], v2, s[28:31], s56 offen offset:2176 nt
    s_addk_i32 s56, 0x4000
    s_waitcnt vmcnt(5)
    buffer_load_dwordx4 v[152:155], v4, s[36:39], s58 offen nt
    s_addk_i32 s58, 0x2000
    s_waitcnt vmcnt(5)
    buffer_load_dwordx4 a[16:19], v2, s[28:31], s56 offen offset:0 nt
    s_waitcnt vmcnt(5)
    buffer_load_dwordx4 v[156:159], v4, s[36:39], s58 offen nt
    s_mov_b32 s58, 0x40000
    s_waitcnt vmcnt(5)
    buffer_load_dwordx4 a[20:23], v2, s[28:31], s56 offen offset:128 nt
    s_waitcnt vmcnt(5)
    buffer_load_dwordx4 v[160:163], v4, s[36:39], s58 offen nt
    s_addk_i32 s58, 0x2000
    s_waitcnt vmcnt(5)
    buffer_load_dwordx4 a[24:27], v2, s[28:31], s56 offen offset:2048 nt
    s_waitcnt vmcnt(5)
    buffer_load_dwordx4 v[164:167], v4, s[36:39], s58 offen nt
    s_addk_i32 s58, 0x2000
    s_waitcnt vmcnt(5)
    buffer_load_dwordx4 a[28:31], v2, s[28:31], s56 offen offset:2176 nt
    s_addk_i32 s56, 0x4000
    s_waitcnt vmcnt(5)
    buffer_load_dwordx4 v[168:171], v4, s[36:39], s58 offen nt
    s_addk_i32 s58, 0x2000
    s_waitcnt vmcnt(5)
    buffer_load_dwordx4 a[32:35], v2, s[28:31], s56 offen offset:0 nt
    s_waitcnt vmcnt(5)
    buffer_load_dwordx4 v[172:175], v4, s[36:39], s58 offen nt
    s_addk_i32 s58, 0x2000
    s_waitcnt vmcnt(5)
    buffer_load_dwordx4 a[36:39], v2, s[28:31], s56 offen offset:128 nt
    s_waitcnt vmcnt(5)
    buffer_load_dwordx4 v[176:179], v4, s[36:39], s58 offen nt
    s_addk_i32 s58, 0x2000
    s_waitcnt vmcnt(5)
    buffer_load_dwordx4 a[40:43], v2, s[28:31], s56 offen offset:2048 nt
    s_waitcnt vmcnt(5)
    buffer_load_dwordx4 v[180:183], v4, s[36:39], s58 offen nt
    s_addk_i32 s58, 0x2000
    s_waitcnt vmcnt(5)
    buffer_load_dwordx4 a[44:47], v2, s[28:31], s56 offen offset:2176 nt
    s_addk_i32 s56, 0x4000
    s_waitcnt vmcnt(5)
    buffer_load_dwordx4 v[184:187], v4, s[36:39], s58 offen nt
    s_addk_i32 s58, 0x2000
    s_waitcnt vmcnt(5)
    buffer_load_dwordx4 a[48:51], v2, s[28:31], s56 offen offset:0 nt
    s_waitcnt vmcnt(5)
    buffer_load_dwordx4 v[188:191], v4, s[36:39], s58 offen nt
    s_lshl_b32 s4, s2, 18
    s_add_u32 s36, s12, s4
    s_addc_u32 s37, s13, 0
    s_mov_b32 s38, 0x40000
    s_mov_b32 s39, 0x20000
    v_perm_b32 v40, v132, v128, s60
    v_perm_b32 v41, v140, v136, s60
    v_perm_b32 v42, v148, v144, s60
    v_perm_b32 v43, v156, v152, s60
    s_waitcnt vmcnt(5)
    buffer_load_dwordx4 a[52:55], v2, s[28:31], s56 offen offset:128 nt
    v_perm_b32 v44, v132, v128, s61
    v_perm_b32 v45, v140, v136, s61
    v_perm_b32 v46, v148, v144, s61
    v_perm_b32 v47, v156, v152, s61
    s_waitcnt vmcnt(5)
    buffer_load_dwordx4 a[56:59], v2, s[28:31], s56 offen offset:2048 nt
    v_perm_b32 v48, v133, v129, s60
    v_perm_b32 v49, v141, v137, s60
    v_perm_b32 v50, v149, v145, s60
    v_perm_b32 v51, v157, v153, s60
    s_waitcnt vmcnt(5)
    buffer_load_dwordx4 a[60:63], v2, s[28:31], s56 offen offset:2176 nt
    s_addk_i32 s56, 0x4000
    v_perm_b32 v52, v133, v129, s61
    v_perm_b32 v53, v141, v137, s61
    v_perm_b32 v54, v149, v145, s61
    v_perm_b32 v55, v157, v153, s61
    s_waitcnt vmcnt(5)
    buffer_load_dwordx4 a[64:67], v2, s[28:31], s56 offen offset:0 nt
    v_mfma_f32_16x16x32_bf16 v[64:67], v[40:43], v[56:59], 0
    v_mfma_f32_16x16x32_bf16 v[68:71], v[44:47], v[56:59], 0
    v_perm_b32 v40, v134, v130, s60
    v_perm_b32 v41, v142, v138, s60
    v_perm_b32 v42, v150, v146, s60
    v_perm_b32 v43, v158, v154, s60
    s_waitcnt vmcnt(5)
    buffer_load_dwordx4 a[68:71], v2, s[28:31], s56 offen offset:128 nt
    v_perm_b32 v44, v134, v130, s61
    v_perm_b32 v45, v142, v138, s61
    v_perm_b32 v46, v150, v146, s61
    v_perm_b32 v47, v158, v154, s61
    s_waitcnt vmcnt(5)
    buffer_load_dwordx4 a[72:75], v2, s[28:31], s56 offen offset:2048 nt
    v_mfma_f32_16x16x32_bf16 v[72:75], v[48:51], v[56:59], 0
    v_mfma_f32_16x16x32_bf16 v[76:79], v[52:55], v[56:59], 0
    v_perm_b32 v48, v135, v131, s60
    v_perm_b32 v49, v143, v139, s60
    v_perm_b32 v50, v151, v147, s60
    v_perm_b32 v51, v159, v155, s60
    v_perm_b32 v52, v135, v131, s61
    v_perm_b32 v53, v143, v139, s61
    v_perm_b32 v54, v151, v147, s61
    v_perm_b32 v55, v159, v155, s61
    v_mfma_f32_16x16x32_bf16 v[80:83], v[40:43], v[56:59], 0
    v_mfma_f32_16x16x32_bf16 v[84:87], v[44:47], v[56:59], 0
    v_mfma_f32_16x16x32_bf16 v[88:91], v[48:51], v[56:59], 0
    v_mfma_f32_16x16x32_bf16 v[92:95], v[52:55], v[56:59], 0
    v_perm_b32 v40, v164, v160, s60
    v_perm_b32 v41, v172, v168, s60
    v_perm_b32 v42, v180, v176, s60
    v_perm_b32 v43, v188, v184, s60
    v_perm_b32 v44, v164, v160, s61
    v_perm_b32 v45, v172, v168, s61
    v_perm_b32 v46, v180, v176, s61
    v_perm_b32 v47, v188, v184, s61
    v_perm_b32 v48, v165, v161, s60
    v_perm_b32 v49, v173, v169, s60
    v_perm_b32 v50, v181, v177, s60
    v_perm_b32 v51, v189, v185, s60
    v_perm_b32 v52, v165, v161, s61
    v_perm_b32 v53, v173, v169, s61
    v_perm_b32 v54, v181, v177, s61
    v_perm_b32 v55, v189, v185, s61
    v_mfma_f32_16x16x32_bf16 v[64:67], v[40:43], v[60:63], v[64:67]
    v_mfma_f32_16x16x32_bf16 v[68:71], v[44:47], v[60:63], v[68:71]
    v_perm_b32 v40, v166, v162, s60
    v_perm_b32 v41, v174, v170, s60
    v_perm_b32 v42, v182, v178, s60
    v_perm_b32 v43, v190, v186, s60
    v_perm_b32 v44, v166, v162, s61
    v_perm_b32 v45, v174, v170, s61
    v_perm_b32 v46, v182, v178, s61
    v_perm_b32 v47, v190, v186, s61
    v_mfma_f32_16x16x32_bf16 v[72:75], v[48:51], v[60:63], v[72:75]
    v_mfma_f32_16x16x32_bf16 v[76:79], v[52:55], v[60:63], v[76:79]
    v_perm_b32 v48, v167, v163, s60
    v_perm_b32 v49, v175, v171, s60
    v_perm_b32 v50, v183, v179, s60
    v_perm_b32 v51, v191, v187, s60
    v_perm_b32 v52, v167, v163, s61
    v_perm_b32 v53, v175, v171, s61
    v_perm_b32 v54, v183, v179, s61
    v_perm_b32 v55, v191, v187, s61
    v_mfma_f32_16x16x32_bf16 v[80:83], v[40:43], v[60:63], v[80:83]
    v_mfma_f32_16x16x32_bf16 v[84:87], v[44:47], v[60:63], v[84:87]
    v_mfma_f32_16x16x32_bf16 v[88:91], v[48:51], v[60:63], v[88:91]
    v_mfma_f32_16x16x32_bf16 v[92:95], v[52:55], v[60:63], v[92:95]
    s_mov_b32 exec_lo, 0x00030003
    s_mov_b32 exec_hi, 0x00030003
    ds_write_b128 v12, v[64:67] offset:0
    ds_write_b128 v12, v[68:71] offset:144
    ds_write_b128 v12, v[72:75] offset:288
    ds_write_b128 v12, v[76:79] offset:432
    ds_write_b128 v12, v[80:83] offset:576
    ds_write_b128 v12, v[84:87] offset:720
    ds_write_b128 v12, v[88:91] offset:864
    ds_write_b128 v12, v[92:95] offset:1008
    s_mov_b64 exec, -1
    s_waitcnt lgkmcnt(0)
    s_barrier
    s_cmp_eq_u32 s26, 0
    s_cbranch_scc1 L_qpub
    s_waitcnt vmcnt(5)
    buffer_load_dwordx4 a[76:79], v2, s[28:31], s56 offen offset:2176 nt
    s_addk_i32 s56, 0x4000
    s_waitcnt vmcnt(5)
    buffer_load_dwordx4 a[80:83], v2, s[28:31], s56 offen offset:0 nt
    s_waitcnt vmcnt(5)
    buffer_load_dwordx4 a[84:87], v2, s[28:31], s56 offen offset:128 nt
    s_waitcnt vmcnt(5)
    buffer_load_dwordx4 a[88:91], v2, s[28:31], s56 offen offset:2048 nt
    s_waitcnt vmcnt(5)
    buffer_load_dwordx4 a[92:95], v2, s[28:31], s56 offen offset:2176 nt
    s_addk_i32 s56, 0x4000
    s_waitcnt vmcnt(5)
    buffer_load_dwordx4 a[96:99], v2, s[28:31], s56 offen offset:0 nt
    s_waitcnt vmcnt(5)
    buffer_load_dwordx4 a[100:103], v2, s[28:31], s56 offen offset:128 nt
    s_waitcnt vmcnt(5)
    buffer_load_dwordx4 a[104:107], v2, s[28:31], s56 offen offset:2048 nt
    s_waitcnt vmcnt(5)
    buffer_load_dwordx4 a[108:111], v2, s[28:31], s56 offen offset:2176 nt
    s_addk_i32 s56, 0x4000
    s_waitcnt vmcnt(5)
    buffer_load_dwordx4 a[112:115], v2, s[28:31], s56 offen offset:0 nt
    s_waitcnt vmcnt(5)
    buffer_load_dwordx4 a[116:119], v2, s[28:31], s56 offen offset:128 nt
    s_waitcnt vmcnt(5)
    buffer_load_dwordx4 a[120:123], v2, s[28:31], s56 offen offset:2048 nt
    s_waitcnt vmcnt(5)
    buffer_load_dwordx4 a[124:127], v2, s[28:31], s56 offen offset:2176 nt
    s_addk_i32 s56, 0x4000
    s_waitcnt vmcnt(5)
    buffer_load_dwordx4 a[128:131], v2, s[28:31], s56 offen offset:0 nt
    s_waitcnt vmcnt(5)
    buffer_load_dwordx4 a[132:135], v2, s[28:31], s56 offen offset:128 nt
    s_waitcnt vmcnt(5)
    buffer_load_dwordx4 a[136:139], v2, s[28:31], s56 offen offset:2048 nt
    s_waitcnt vmcnt(5)
    buffer_load_dwordx4 a[140:143], v2, s[28:31], s56 offen offset:2176 nt
    s_addk_i32 s56, 0x4000
    s_waitcnt vmcnt(5)
    buffer_load_dwordx4 a[144:147], v2, s[28:31], s56 offen offset:0 nt
    s_waitcnt vmcnt(5)
    buffer_load_dwordx4 a[148:151], v2, s[28:31], s56 offen offset:128 nt
    s_waitcnt vmcnt(5)
    buffer_load_dwordx4 a[152:155], v2, s[28:31], s56 offen offset:2048 nt
L_qpubdone:
    v_lshlrev_b32 v10, 13, v6
    v_lshrrev_b32 v11, 5, v1
    v_lshl_or_b32 v10, v11, 12, v10
    v_and_b32 v12, 31, v1
    v_lshl_or_b32 v10, v12, 4, v10
    v_lshl_add_u32 v13, v6, 1, v11
    v_mul_u32_u24 v13, 272, v13
    v_lshl_add_u32 v13, v12, 3, v13
    v_and_b32 v14, 7, v1
    v_mul_u32_u24 v14, 272, v14
    v_lshl_add_u32 v14, v7, 5, v14
    v_bfe_u32 v11, v1, 3, 1
    v_lshl_add_u32 v14, v11, 4, v14
    s_lshl_b32 s4, s59, 15
    s_lshl_b32 s5, s3, 9
    s_add_u32 s58, s4, s5
    s_add_u32 s71, s58, 0x20000
    v_and_b32 v11, 1, v1
    v_lshlrev_b32 v11, 7, v11
    s_lshl_b32 s4, s59, 2
    v_add_u32 v11, s4, v11
    v_lshlrev_b32 v4, 12, v7
    v_lshl_or_b32 v4, v6, 8, v4
    v_lshl_or_b32 v4, v9, 4, v4
    s_waitcnt vmcnt(5)
    buffer_load_dwordx4 a[156:159], v2, s[28:31], s56 offen offset:2176 nt
    s_addk_i32 s56, 0x4000
    s_waitcnt vmcnt(5)
    buffer_load_dwordx4 a[160:163], v2, s[28:31], s56 offen offset:0 nt
    s_waitcnt vmcnt(5)
    buffer_load_dwordx4 a[164:167], v2, s[28:31], s56 offen offset:128 nt
    s_waitcnt vmcnt(5)
    buffer_load_dwordx4 a[168:171], v2, s[28:31], s56 offen offset:2048 nt
    s_waitcnt vmcnt(5)
    buffer_load_dwordx4 a[172:175], v2, s[28:31], s56 offen offset:2176 nt
    s_addk_i32 s56, 0x4000
    s_waitcnt vmcnt(5)
    buffer_load_dwordx4 a[176:179], v2, s[28:31], s56 offen offset:0 nt
    s_waitcnt vmcnt(5)
    buffer_load_dwordx4 a[180:183], v2, s[28:31], s56 offen offset:128 nt
    s_waitcnt vmcnt(5)
    buffer_load_dwordx4 a[184:187], v2, s[28:31], s56 offen offset:2048 nt
    s_waitcnt vmcnt(5)
    buffer_load_dwordx4 a[188:191], v2, s[28:31], s56 offen offset:2176 nt
    s_addk_i32 s56, 0x4000
    s_waitcnt vmcnt(5)
    buffer_load_dwordx4 a[192:195], v2, s[28:31], s56 offen offset:0 nt
    s_waitcnt vmcnt(5)
    buffer_load_dwordx4 a[196:199], v2, s[28:31], s56 offen offset:128 nt
    s_waitcnt vmcnt(5)
    buffer_load_dwordx4 a[200:203], v2, s[28:31], s56 offen offset:2048 nt
    s_waitcnt vmcnt(5)
    buffer_load_dwordx4 a[204:207], v2, s[28:31], s56 offen offset:2176 nt
    s_addk_i32 s56, 0x4000
    s_waitcnt vmcnt(5)
    buffer_load_dwordx4 a[208:211], v2, s[28:31], s56 offen offset:0 nt
    s_waitcnt vmcnt(5)
    buffer_load_dwordx4 a[212:215], v2, s[28:31], s56 offen offset:128 nt
    s_waitcnt vmcnt(5)
    buffer_load_dwordx4 a[216:219], v2, s[28:31], s56 offen offset:2048 nt
    s_waitcnt vmcnt(5)
    buffer_load_dwordx4 a[220:223], v2, s[28:31], s56 offen offset:2176 nt
    s_addk_i32 s56, 0x4000
    s_waitcnt vmcnt(5)
    buffer_load_dwordx4 a[224:227], v2, s[28:31], s56 offen offset:0 nt
    s_waitcnt vmcnt(5)
    buffer_load_dwordx4 a[228:231], v2, s[28:31], s56 offen offset:128 nt
    s_waitcnt vmcnt(5)
    buffer_load_dwordx4 a[232:235], v2, s[28:31], s56 offen offset:2048 nt
    s_waitcnt vmcnt(5)
    buffer_load_dwordx4 a[236:239], v2, s[28:31], s56 offen offset:2176 nt
    s_addk_i32 s56, 0x4000
    s_waitcnt vmcnt(5)
    buffer_load_dwordx4 a[240:243], v2, s[28:31], s56 offen offset:0 nt
    s_waitcnt vmcnt(5)
    buffer_load_dwordx4 a[244:247], v2, s[28:31], s56 offen offset:128 nt
    s_waitcnt vmcnt(5)
    buffer_load_dwordx4 a[248:251], v2, s[28:31], s56 offen offset:2048 nt
    s_waitcnt vmcnt(5)
    buffer_load_dwordx4 a[252:255], v2, s[28:31], s56 offen offset:2176 nt
    s_lshl_b32 s56, s26, 12
    s_waitcnt vmcnt(5)
    buffer_load_dwordx4 v[128:131], v2, s[36:39], s56 offen offset:0 nt
    s_waitcnt vmcnt(5)
    buffer_load_dwordx4 v[132:135], v2, s[36:39], s56 offen offset:128 nt
    s_waitcnt vmcnt(5)
    buffer_load_dwordx4 v[136:139], v2, s[36:39], s56 offen offset:2048 nt
    s_waitcnt vmcnt(5)
    buffer_load_dwordx4 v[140:143], v2, s[36:39], s56 offen offset:2176 nt
    s_addk_i32 s56, 0x4000
    s_waitcnt vmcnt(5)
    buffer_load_dwordx4 v[144:147], v2, s[36:39], s56 offen offset:0 nt
    s_waitcnt vmcnt(5)
    buffer_load_dwordx4 v[148:151], v2, s[36:39], s56 offen offset:128 nt
    s_waitcnt vmcnt(5)
    buffer_load_dwordx4 v[152:155], v2, s[36:39], s56 offen offset:2048 nt
    s_waitcnt vmcnt(5)
    buffer_load_dwordx4 v[156:159], v2, s[36:39], s56 offen offset:2176 nt
    s_addk_i32 s56, 0x4000
    s_waitcnt vmcnt(5)
    buffer_load_dwordx4 v[160:163], v2, s[36:39], s56 offen offset:0 nt
    s_waitcnt vmcnt(5)
    buffer_load_dwordx4 v[164:167], v2, s[36:39], s56 offen offset:128 nt
    s_waitcnt vmcnt(5)
    buffer_load_dwordx4 v[168:171], v2, s[36:39], s56 offen offset:2048 nt
    s_waitcnt vmcnt(5)
    buffer_load_dwordx4 v[172:175], v2, s[36:39], s56 offen offset:2176 nt
    s_addk_i32 s56, 0x4000
    global_load_dword v12, v11, s[22:23] sc1
    s_waitcnt vmcnt(6)
    buffer_load_dwordx4 v[176:179], v2, s[36:39], s56 offen offset:0 nt
    s_waitcnt vmcnt(6)
    buffer_load_dwordx4 v[180:183], v2, s[36:39], s56 offen offset:128 nt
    s_waitcnt vmcnt(6)
    buffer_load_dwordx4 v[184:187], v2, s[36:39], s56 offen offset:2048 nt
    s_waitcnt vmcnt(6)
    buffer_load_dwordx4 v[188:191], v2, s[36:39], s56 offen offset:2176 nt
    s_addk_i32 s56, 0x4000
    s_waitcnt vmcnt(6)
    buffer_load_dwordx4 v[192:195], v2, s[36:39], s56 offen offset:0 nt
    s_waitcnt vmcnt(6)
    buffer_load_dwordx4 v[196:199], v2, s[36:39], s56 offen offset:128 nt
    s_waitcnt vmcnt(5)
    buffer_load_dwordx4 v[200:203], v2, s[36:39], s56 offen offset:2048 nt
    v_cmp_gt_u32 vcc, 32, v12
    s_cbranch_vccnz L_qslow
    buffer_load_dwordx4 v[64:67], v10, s[48:51], s58 offen offset:0 sc1
    buffer_load_dwordx4 v[68:71], v10, s[48:51], s58 offen offset:1024 sc1
    s_waitcnt vmcnt(7)
    buffer_load_dwordx4 v[204:207], v2, s[36:39], s56 offen offset:2176 nt
    s_addk_i32 s56, 0x4000
    buffer_load_dwordx4 v[72:75], v10, s[48:51], s58 offen offset:2048 sc1
    buffer_load_dwordx4 v[76:79], v10, s[48:51], s58 offen offset:3072 sc1
    s_waitcnt vmcnt(9)
    buffer_load_dwordx4 v[208:211], v2, s[36:39], s56 offen offset:0 nt
    buffer_load_dwordx4 v[80:83], v10, s[48:51], s71 offen offset:0 sc1
    buffer_load_dwordx4 v[84:87], v10, s[48:51], s71 offen offset:1024 sc1
    s_waitcnt vmcnt(11)
    buffer_load_dwordx4 v[212:215], v2, s[36:39], s56 offen offset:128 nt
    buffer_load_dwordx4 v[88:91], v10, s[48:51], s71 offen offset:2048 sc1
    buffer_load_dwordx4 v[92:95], v10, s[48:51], s71 offen offset:3072 sc1
    s_waitcnt vmcnt(13)
    buffer_load_dwordx4 v[216:219], v2, s[36:39], s56 offen offset:2048 nt
    s_waitcnt vmcnt(13)
    buffer_load_dwordx4 v[220:223], v2, s[36:39], s56 offen offset:2176 nt
    s_addk_i32 s56, 0x4000
    s_waitcnt vmcnt(13)
    buffer_load_dwordx4 v[224:227], v2, s[36:39], s56 offen offset:0 nt
    s_waitcnt vmcnt(11)
    buffer_load_dwordx4 v[228:231], v2, s[36:39], s56 offen offset:128 nt
    s_waitcnt vmcnt(9)
    buffer_load_dwordx4 v[232:235], v2, s[36:39], s56 offen offset:2048 nt
    s_waitcnt vmcnt(7)
    buffer_load_dwordx4 v[236:239], v2, s[36:39], s56 offen offset:2176 nt
    s_addk_i32 s56, 0x4000
    s_waitcnt vmcnt(5)
    buffer_load_dwordx4 v[240:243], v2, s[36:39], s56 offen offset:0 nt
    s_waitcnt vmcnt(5)
    buffer_load_dwordx4 v[244:247], v2, s[36:39], s56 offen offset:128 nt
    s_waitcnt vmcnt(5)
    buffer_load_dwordx4 v[248:251], v2, s[36:39], s56 offen offset:2048 nt
    s_waitcnt vmcnt(5)
    buffer_load_dwordx4 v[252:255], v2, s[36:39], s56 offen offset:2176 nt
    s_addk_i32 s56, 0x4000
L_qjoin:
    v_add_f32 v64, v64, v72
    v_add_f32 v65, v65, v73
    v_add_f32 v66, v66, v74
    v_add_f32 v67, v67, v75
    v_add_f32 v68, v68, v76
    v_add_f32 v69, v69, v77
    v_add_f32 v70, v70, v78
    v_add_f32 v71, v71, v79
    v_add_f32 v64, v64, v68
    v_add_f32 v65, v65, v69
    v_add_f32 v66, v66, v70
    v_add_f32 v67, v67, v71
    v_cvt_pk_bf16_f32 v68, v64, v65
    v_cvt_pk_bf16_f32 v69, v66, v67
    ds_write_b64 v13, v[68:69] offset:6656
    v_add_f32 v80, v80, v88
    v_add_f32 v81, v81, v89
    v_add_f32 v82, v82, v90
    v_add_f32 v83, v83, v91
    v_add_f32 v84, v84, v92
    v_add_f32 v85, v85, v93
    v_add_f32 v86, v86, v94
    v_add_f32 v87, v87, v95
    v_add_f32 v80, v80, v84
    v_add_f32 v81, v81, v85
    v_add_f32 v82, v82, v86
    v_add_f32 v83, v83, v87
    v_cvt_pk_bf16_f32 v84, v80, v81
    v_cvt_pk_bf16_f32 v85, v82, v83
    ds_write_b64 v13, v[84:85] offset:8832
    s_waitcnt lgkmcnt(0)
    s_barrier
    ds_read_b128 v[16:19], v14 offset:6656
    ds_read_b128 v[20:23], v14 offset:6784
    ds_read_b128 v[56:59], v14 offset:8832
    ds_read_b128 v[60:63], v14 offset:8960
    s_waitcnt lgkmcnt(0)
    v_mfma_f32_16x16x32_bf16 v[24:27], a[0:3], v[16:19], 0
    v_mfma_f32_16x16x32_bf16 v[24:27], a[4:7], v[20:23], v[24:27]
    s_waitcnt vmcnt(5)
    buffer_load_dwordx4 a[0:3], v2, s[36:39], s56 offen offset:0 nt
    v_mfma_f32_16x16x32_bf16 v[28:31], a[8:11], v[16:19], 0
    v_mfma_f32_16x16x32_bf16 v[28:31], a[12:15], v[20:23], v[28:31]
    s_waitcnt vmcnt(5)
    buffer_load_dwordx4 a[4:7], v2, s[36:39], s56 offen offset:128 nt
    v_mfma_f32_16x16x32_bf16 v[32:35], a[16:19], v[16:19], 0
    v_mfma_f32_16x16x32_bf16 v[32:35], a[20:23], v[20:23], v[32:35]
    s_waitcnt vmcnt(5)
    buffer_load_dwordx4 a[8:11], v2, s[36:39], s56 offen offset:2048 nt
    v_mfma_f32_16x16x32_bf16 v[36:39], a[24:27], v[16:19], 0
    v_mfma_f32_16x16x32_bf16 v[36:39], a[28:31], v[20:23], v[36:39]
    s_waitcnt vmcnt(5)
    buffer_load_dwordx4 a[12:15], v2, s[36:39], s56 offen offset:2176 nt
    s_addk_i32 s56, 0x4000
    v_add_f32_dpp v64, v25, v24 row_ror:8 row_mask:0xf bank_mask:0x3
    v_add_f32_dpp v64, v26, v27 row_ror:8 row_mask:0xf bank_mask:0xc
    v_mfma_f32_16x16x32_bf16 v[24:27], a[32:35], v[16:19], 0
    v_mfma_f32_16x16x32_bf16 v[24:27], a[36:39], v[20:23], v[24:27]
    s_waitcnt vmcnt(5)
    buffer_load_dwordx4 a[16:19], v2, s[36:39], s56 offen offset:0 nt
    v_add_f32_dpp v65, v29, v28 row_ror:8 row_mask:0xf bank_mask:0x3
    v_add_f32_dpp v65, v30, v31 row_ror:8 row_mask:0xf bank_mask:0xc
    v_mfma_f32_16x16x32_bf16 v[28:31], a[40:43], v[16:19], 0
    v_mfma_f32_16x16x32_bf16 v[28:31], a[44:47], v[20:23], v[28:31]
    s_waitcnt vmcnt(5)
    buffer_load_dwordx4 a[20:23], v2, s[36:39], s56 offen offset:128 nt
    v_add_f32_dpp v66, v33, v32 row_ror:8 row_mask:0xf bank_mask:0x3
    v_add_f32_dpp v66, v34, v35 row_ror:8 row_mask:0xf bank_mask:0xc
    v_mfma_f32_16x16x32_bf16 v[32:35], a[48:51], v[16:19], 0
    v_mfma_f32_16x16x32_bf16 v[32:35], a[52:55], v[20:23], v[32:35]
    s_waitcnt vmcnt(5)
    buffer_load_dwordx4 a[24:27], v2, s[36:39], s56 offen offset:2048 nt
    v_add_f32_dpp v67, v37, v36 row_ror:8 row_mask:0xf bank_mask:0x3
    v_add_f32_dpp v67, v38, v39 row_ror:8 row_mask:0xf bank_mask:0xc
    v_mfma_f32_16x16x32_bf16 v[36:39], a[56:59], v[16:19], 0
    v_mfma_f32_16x16x32_bf16 v[36:39], a[60:63], v[20:23], v[36:39]
    s_waitcnt vmcnt(5)
    buffer_load_dwordx4 a[28:31], v2, s[36:39], s56 offen offset:2176 nt
    s_addk_i32 s56, 0x4000
    v_add_f32_dpp v68, v25, v24 row_ror:8 row_mask:0xf bank_mask:0x3
    v_add_f32_dpp v68, v26, v27 row_ror:8 row_mask:0xf bank_mask:0xc
    v_mfma_f32_16x16x32_bf16 v[24:27], a[64:67], v[16:19], 0
    v_mfma_f32_16x16x32_bf16 v[24:27], a[68:71], v[20:23], v[24:27]
    s_waitcnt vmcnt(5)
    buffer_load_dwordx4 a[32:35], v2, s[36:39], s56 offen offset:0 nt
    v_add_f32_dpp v69, v29, v28 row_ror:8 row_mask:0xf bank_mask:0x3
    v_add_f32_dpp v69, v30, v31 row_ror:8 row_mask:0xf bank_mask:0xc
    v_mfma_f32_16x16x32_bf16 v[28:31], a[72:75], v[16:19], 0
    v_mfma_f32_16x16x32_bf16 v[28:31], a[76:79], v[20:23], v[28:31]
    s_waitcnt vmcnt(5)
    buffer_load_dwordx4 a[36:39], v2, s[36:39], s56 offen offset:128 nt
    v_add_f32_dpp v70, v33, v32 row_ror:8 row_mask:0xf bank_mask:0x3
    v_add_f32_dpp v70, v34, v35 row_ror:8 row_mask:0xf bank_mask:0xc
    v_mfma_f32_16x16x32_bf16 v[32:35], a[80:83], v[16:19], 0
    v_mfma_f32_16x16x32_bf16 v[32:35], a[84:87], v[20:23], v[32:35]
    s_waitcnt vmcnt(5)
    buffer_load_dwordx4 a[40:43], v2, s[36:39], s56 offen offset:2048 nt
    v_add_f32_dpp v71, v37, v36 row_ror:8 row_mask:0xf bank_mask:0x3
    v_add_f32_dpp v71, v38, v39 row_ror:8 row_mask:0xf bank_mask:0xc
    v_mfma_f32_16x16x32_bf16 v[36:39], a[88:91], v[16:19], 0
    v_mfma_f32_16x16x32_bf16 v[36:39], a[92:95], v[20:23], v[36:39]
    s_waitcnt vmcnt(5)
    buffer_load_dwordx4 a[44:47], v2, s[36:39], s56 offen offset:2176 nt
    s_addk_i32 s56, 0x4000
    v_add_f32_dpp v72, v25, v24 row_ror:8 row_mask:0xf bank_mask:0x3
    v_add_f32_dpp v72, v26, v27 row_ror:8 row_mask:0xf bank_mask:0xc
    v_mfma_f32_16x16x32_bf16 v[24:27], a[96:99], v[16:19], 0
    v_mfma_f32_16x16x32_bf16 v[24:27], a[100:103], v[20:23], v[24:27]
    s_waitcnt vmcnt(5)
    buffer_load_dwordx4 a[48:51], v2, s[36:39], s56 offen offset:0 nt
    v_add_f32_dpp v73, v29, v28 row_ror:8 row_mask:0xf bank_mask:0x3
    v_add_f32_dpp v73, v30, v31 row_ror:8 row_mask:0xf bank_mask:0xc
    v_mfma_f32_16x16x32_bf16 v[28:31], a[104:107], v[16:19], 0
    v_mfma_f32_16x16x32_bf16 v[28:31], a[108:111], v[20:23], v[28:31]
    s_waitcnt vmcnt(5)
    buffer_load_dwordx4 a[52:55], v2, s[36:39], s56 offen offset:128 nt
    v_add_f32_dpp v74, v33, v32 row_ror:8 row_mask:0xf bank_mask:0x3
    v_add_f32_dpp v74, v34, v35 row_ror:8 row_mask:0xf bank_mask:0xc
    v_mfma_f32_16x16x32_bf16 v[32:35], a[112:115], v[16:19], 0
    v_mfma_f32_16x16x32_bf16 v[32:35], a[116:119], v[20:23], v[32:35]
    s_waitcnt vmcnt(5)
    buffer_load_dwordx4 a[56:59], v2, s[36:39], s56 offen offset:2048 nt
    v_add_f32_dpp v75, v37, v36 row_ror:8 row_mask:0xf bank_mask:0x3
    v_add_f32_dpp v75, v38, v39 row_ror:8 row_mask:0xf bank_mask:0xc
    v_mfma_f32_16x16x32_bf16 v[36:39], a[120:123], v[16:19], 0
    v_mfma_f32_16x16x32_bf16 v[36:39], a[124:127], v[20:23], v[36:39]
    s_waitcnt vmcnt(5)
    buffer_load_dwordx4 a[60:63], v2, s[36:39], s56 offen offset:2176 nt
    s_addk_i32 s56, 0x4000
    v_add_f32_dpp v76, v25, v24 row_ror:8 row_mask:0xf bank_mask:0x3
    v_add_f32_dpp v76, v26, v27 row_ror:8 row_mask:0xf bank_mask:0xc
    v_mfma_f32_16x16x32_bf16 v[24:27], v[128:131], v[56:59], 0
    v_mfma_f32_16x16x32_bf16 v[24:27], v[132:135], v[60:63], v[24:27]
    s_waitcnt vmcnt(5)
    buffer_load_dwordx4 a[64:67], v2, s[36:39], s56 offen offset:0 nt
    v_add_f32_dpp v77, v29, v28 row_ror:8 row_mask:0xf bank_mask:0x3
    v_add_f32_dpp v77, v30, v31 row_ror:8 row_mask:0xf bank_mask:0xc
    v_mfma_f32_16x16x32_bf16 v[28:31], v[136:139], v[56:59], 0
    v_mfma_f32_16x16x32_bf16 v[28:31], v[140:143], v[60:63], v[28:31]
    s_waitcnt vmcnt(5)
    buffer_load_dwordx4 a[68:71], v2, s[36:39], s56 offen offset:128 nt
    v_add_f32_dpp v78, v33, v32 row_ror:8 row_mask:0xf bank_mask:0x3
    v_add_f32_dpp v78, v34, v35 row_ror:8 row_mask:0xf bank_mask:0xc
    v_mfma_f32_16x16x32_bf16 v[32:35], v[144:147], v[56:59], 0
    v_mfma_f32_16x16x32_bf16 v[32:35], v[148:151], v[60:63], v[32:35]
    s_waitcnt vmcnt(5)
    buffer_load_dwordx4 a[72:75], v2, s[36:39], s56 offen offset:2048 nt
    v_add_f32_dpp v79, v37, v36 row_ror:8 row_mask:0xf bank_mask:0x3
    v_add_f32_dpp v79, v38, v39 row_ror:8 row_mask:0xf bank_mask:0xc
    v_mfma_f32_16x16x32_bf16 v[36:39], v[152:155], v[56:59], 0
    v_mfma_f32_16x16x32_bf16 v[36:39], v[156:159], v[60:63], v[36:39]
    s_waitcnt vmcnt(5)
    buffer_load_dwordx4 a[76:79], v2, s[36:39], s56 offen offset:2176 nt
    s_addk_i32 s56, 0x4000
    v_add_f32_dpp v96, v25, v24 row_ror:8 row_mask:0xf bank_mask:0x3
    v_add_f32_dpp v96, v26, v27 row_ror:8 row_mask:0xf bank_mask:0xc
    v_mfma_f32_16x16x32_bf16 v[24:27], v[160:163], v[56:59], 0
    v_mfma_f32_16x16x32_bf16 v[24:27], v[164:167], v[60:63], v[24:27]
    s_waitcnt vmcnt(5)
    buffer_load_dwordx4 a[80:83], v2, s[36:39], s56 offen offset:0 nt
    v_add_f32_dpp v97, v29, v28 row_ror:8 row_mask:0xf bank_mask:0x3
    v_add_f32_dpp v97, v30, v31 row_ror:8 row_mask:0xf bank_mask:0xc
    v_mfma_f32_16x16x32_bf16 v[28:31], v[168:171], v[56:59], 0
    v_mfma_f32_16x16x32_bf16 v[28:31], v[172:175], v[60:63], v[28:31]
    s_waitcnt vmcnt(5)
    buffer_load_dwordx4 a[84:87], v2, s[36:39], s56 offen offset:128 nt
    v_add_f32_dpp v98, v33, v32 row_ror:8 row_mask:0xf bank_mask:0x3
    v_add_f32_dpp v98, v34, v35 row_ror:8 row_mask:0xf bank_mask:0xc
    v_mfma_f32_16x16x32_bf16 v[32:35], v[176:179], v[56:59], 0
    v_mfma_f32_16x16x32_bf16 v[32:35], v[180:183], v[60:63], v[32:35]
    s_waitcnt vmcnt(5)
    buffer_load_dwordx4 a[88:91], v2, s[36:39], s56 offen offset:2048 nt
    v_add_f32_dpp v99, v37, v36 row_ror:8 row_mask:0xf bank_mask:0x3
    v_add_f32_dpp v99, v38, v39 row_ror:8 row_mask:0xf bank_mask:0xc
    v_mfma_f32_16x16x32_bf16 v[36:39], v[184:187], v[56:59], 0
    v_mfma_f32_16x16x32_bf16 v[36:39], v[188:191], v[60:63], v[36:39]
    s_waitcnt vmcnt(5)
    buffer_load_dwordx4 a[92:95], v2, s[36:39], s56 offen offset:2176 nt
    s_addk_i32 s56, 0x4000
    v_add_f32_dpp v100, v25, v24 row_ror:8 row_mask:0xf bank_mask:0x3
    v_add_f32_dpp v100, v26, v27 row_ror:8 row_mask:0xf bank_mask:0xc
    v_mfma_f32_16x16x32_bf16 v[24:27], v[192:195], v[56:59], 0
    v_mfma_f32_16x16x32_bf16 v[24:27], v[196:199], v[60:63], v[24:27]
    s_waitcnt vmcnt(5)
    buffer_load_dwordx4 a[96:99], v2, s[36:39], s56 offen offset:0 nt
    v_add_f32_dpp v101, v29, v28 row_ror:8 row_mask:0xf bank_mask:0x3
    v_add_f32_dpp v101, v30, v31 row_ror:8 row_mask:0xf bank_mask:0xc
    v_mfma_f32_16x16x32_bf16 v[28:31], v[200:203], v[56:59], 0
    v_mfma_f32_16x16x32_bf16 v[28:31], v[204:207], v[60:63], v[28:31]
    s_waitcnt vmcnt(5)
    buffer_load_dwordx4 a[100:103], v2, s[36:39], s56 offen offset:128 nt
    v_add_f32_dpp v102, v33, v32 row_ror:8 row_mask:0xf bank_mask:0x3
    v_add_f32_dpp v102, v34, v35 row_ror:8 row_mask:0xf bank_mask:0xc
    v_mfma_f32_16x16x32_bf16 v[32:35], v[208:211], v[56:59], 0
    v_mfma_f32_16x16x32_bf16 v[32:35], v[212:215], v[60:63], v[32:35]
    s_waitcnt vmcnt(5)
    buffer_load_dwordx4 a[104:107], v2, s[36:39], s56 offen offset:2048 nt
    v_add_f32_dpp v103, v37, v36 row_ror:8 row_mask:0xf bank_mask:0x3
    v_add_f32_dpp v103, v38, v39 row_ror:8 row_mask:0xf bank_mask:0xc
    v_mfma_f32_16x16x32_bf16 v[36:39], v[216:219], v[56:59], 0
    v_mfma_f32_16x16x32_bf16 v[36:39], v[220:223], v[60:63], v[36:39]
    s_waitcnt vmcnt(5)
    buffer_load_dwordx4 a[108:111], v2, s[36:39], s56 offen offset:2176 nt
    s_addk_i32 s56, 0x4000
    v_add_f32_dpp v104, v25, v24 row_ror:8 row_mask:0xf bank_mask:0x3
    v_add_f32_dpp v104, v26, v27 row_ror:8 row_mask:0xf bank_mask:0xc
    v_mfma_f32_16x16x32_bf16 v[24:27], v[224:227], v[56:59], 0
    v_mfma_f32_16x16x32_bf16 v[24:27], v[228:231], v[60:63], v[24:27]
    s_waitcnt vmcnt(5)
    buffer_load_dwordx4 a[112:115], v2, s[36:39], s56 offen offset:0 nt
    v_add_f32_dpp v105, v29, v28 row_ror:8 row_mask:0xf bank_mask:0x3
    v_add_f32_dpp v105, v30, v31 row_ror:8 row_mask:0xf bank_mask:0xc
    v_mfma_f32_16x16x32_bf16 v[28:31], v[232:235], v[56:59], 0
    v_mfma_f32_16x16x32_bf16 v[28:31], v[236:239], v[60:63], v[28:31]
    s_waitcnt vmcnt(5)
    buffer_load_dwordx4 a[116:119], v2, s[36:39], s56 offen offset:128 nt
    v_add_f32_dpp v106, v33, v32 row_ror:8 row_mask:0xf bank_mask:0x3
    v_add_f32_dpp v106, v34, v35 row_ror:8 row_mask:0xf bank_mask:0xc
    v_mfma_f32_16x16x32_bf16 v[32:35], v[240:243], v[56:59], 0
    v_mfma_f32_16x16x32_bf16 v[32:35], v[244:247], v[60:63], v[32:35]
    s_waitcnt vmcnt(5)
    buffer_load_dwordx4 a[120:123], v2, s[36:39], s56 offen offset:2048 nt
    v_add_f32_dpp v107, v37, v36 row_ror:8 row_mask:0xf bank_mask:0x3
    v_add_f32_dpp v107, v38, v39 row_ror:8 row_mask:0xf bank_mask:0xc
    v_mfma_f32_16x16x32_bf16 v[36:39], v[248:251], v[56:59], 0
    v_mfma_f32_16x16x32_bf16 v[36:39], v[252:255], v[60:63], v[36:39]
    s_waitcnt vmcnt(5)
    buffer_load_dwordx4 a[124:127], v2, s[36:39], s56 offen offset:2176 nt
    s_lshl_b32 s56, s26, 12
    v_add_f32_dpp v108, v25, v24 row_ror:8 row_mask:0xf bank_mask:0x3
    v_add_f32_dpp v108, v26, v27 row_ror:8 row_mask:0xf bank_mask:0xc
    v_mfma_f32_16x16x32_bf16 v[24:27], a[128:131], v[16:19], 0
    v_mfma_f32_16x16x32_bf16 v[24:27], a[132:135], v[20:23], v[24:27]
    v_add_f32_dpp v109, v29, v28 row_ror:8 row_mask:0xf bank_mask:0x3
    v_add_f32_dpp v109, v30, v31 row_ror:8 row_mask:0xf bank_mask:0xc
    v_mfma_f32_16x16x32_bf16 v[28:31], a[136:139], v[16:19], 0
    v_mfma_f32_16x16x32_bf16 v[28:31], a[140:143], v[20:23], v[28:31]
    v_add_f32_dpp v110, v33, v32 row_ror:8 row_mask:0xf bank_mask:0x3
    v_add_f32_dpp v110, v34, v35 row_ror:8 row_mask:0xf bank_mask:0xc
    v_mfma_f32_16x16x32_bf16 v[32:35], a[144:147], v[16:19], 0
    v_mfma_f32_16x16x32_bf16 v[32:35], a[148:151], v[20:23], v[32:35]
    s_waitcnt vmcnt(5)
    buffer_load_dwordx4 v[128:131], v3, s[32:35], s57 offen offset:0 nt
    v_add_f32_dpp v111, v37, v36 row_ror:8 row_mask:0xf bank_mask:0x3
    v_add_f32_dpp v111, v38, v39 row_ror:8 row_mask:0xf bank_mask:0xc
    v_mfma_f32_16x16x32_bf16 v[36:39], a[152:155], v[16:19], 0
    v_mfma_f32_16x16x32_bf16 v[36:39], a[156:159], v[20:23], v[36:39]
    v_add_f32_dpp v80, v25, v24 row_ror:8 row_mask:0xf bank_mask:0x3
    v_add_f32_dpp v80, v26, v27 row_ror:8 row_mask:0xf bank_mask:0xc
    v_mfma_f32_16x16x32_bf16 v[24:27], a[160:163], v[16:19], 0
    v_mfma_f32_16x16x32_bf16 v[24:27], a[164:167], v[20:23], v[24:27]
    v_add_f32_dpp v81, v29, v28 row_ror:8 row_mask:0xf bank_mask:0x3
    v_add_f32_dpp v81, v30, v31 row_ror:8 row_mask:0xf bank_mask:0xc
    v_mfma_f32_16x16x32_bf16 v[28:31], a[168:171], v[16:19], 0
    v_mfma_f32_16x16x32_bf16 v[28:31], a[172:175], v[20:23], v[28:31]
    s_waitcnt vmcnt(5)
    buffer_load_dwordx4 v[132:135], v3, s[32:35], s57 offen offset:1024 nt
    v_add_f32_dpp v82, v33, v32 row_ror:8 row_mask:0xf bank_mask:0x3
    v_add_f32_dpp v82, v34, v35 row_ror:8 row_mask:0xf bank_mask:0xc
    v_mfma_f32_16x16x32_bf16 v[32:35], a[176:179], v[16:19], 0
    v_mfma_f32_16x16x32_bf16 v[32:35], a[180:183], v[20:23], v[32:35]
    v_add_f32_dpp v83, v37, v36 row_ror:8 row_mask:0xf bank_mask:0x3
    v_add_f32_dpp v83, v38, v39 row_ror:8 row_mask:0xf bank_mask:0xc
    v_mfma_f32_16x16x32_bf16 v[36:39], a[184:187], v[16:19], 0
    v_mfma_f32_16x16x32_bf16 v[36:39], a[188:191], v[20:23], v[36:39]
    s_waitcnt vmcnt(5)
    buffer_load_dwordx4 v[136:139], v3, s[32:35], s57 offen offset:2048 nt
    v_add_f32_dpp v84, v25, v24 row_ror:8 row_mask:0xf bank_mask:0x3
    v_add_f32_dpp v84, v26, v27 row_ror:8 row_mask:0xf bank_mask:0xc
    v_mfma_f32_16x16x32_bf16 v[24:27], a[192:195], v[16:19], 0
    v_mfma_f32_16x16x32_bf16 v[24:27], a[196:199], v[20:23], v[24:27]
    v_add_f32_dpp v85, v29, v28 row_ror:8 row_mask:0xf bank_mask:0x3
    v_add_f32_dpp v85, v30, v31 row_ror:8 row_mask:0xf bank_mask:0xc
    v_mfma_f32_16x16x32_bf16 v[28:31], a[200:203], v[16:19], 0
    v_mfma_f32_16x16x32_bf16 v[28:31], a[204:207], v[20:23], v[28:31]
    v_add_f32_dpp v86, v33, v32 row_ror:8 row_mask:0xf bank_mask:0x3
    v_add_f32_dpp v86, v34, v35 row_ror:8 row_mask:0xf bank_mask:0xc
    v_mfma_f32_16x16x32_bf16 v[32:35], a[208:211], v[16:19], 0
    v_mfma_f32_16x16x32_bf16 v[32:35], a[212:215], v[20:23], v[32:35]
    s_waitcnt vmcnt(5)
    buffer_load_dwordx4 v[140:143], v3, s[32:35], s57 offen offset:3072 nt
    s_addk_i32 s57, 0x4000
    v_add_f32_dpp v87, v37, v36 row_ror:8 row_mask:0xf bank_mask:0x3
    v_add_f32_dpp v87, v38, v39 row_ror:8 row_mask:0xf bank_mask:0xc
    v_mfma_f32_16x16x32_bf16 v[36:39], a[216:219], v[16:19], 0
    v_mfma_f32_16x16x32_bf16 v[36:39], a[220:223], v[20:23], v[36:39]
    v_add_f32_dpp v88, v25, v24 row_ror:8 row_mask:0xf bank_mask:0x3
    v_add_f32_dpp v88, v26, v27 row_ror:8 row_mask:0xf bank_mask:0xc
    v_mfma_f32_16x16x32_bf16 v[24:27], a[224:227], v[16:19], 0
    v_mfma_f32_16x16x32_bf16 v[24:27], a[228:231], v[20:23], v[24:27]
    v_add_f32_dpp v89, v29, v28 row_ror:8 row_mask:0xf bank_mask:0x3
    v_add_f32_dpp v89, v30, v31 row_ror:8 row_mask:0xf bank_mask:0xc
    v_mfma_f32_16x16x32_bf16 v[28:31], a[232:235], v[16:19], 0
    v_mfma_f32_16x16x32_bf16 v[28:31], a[236:239], v[20:23], v[28:31]
    s_waitcnt vmcnt(5)
    buffer_load_dwordx4 v[144:147], v3, s[32:35], s57 offen offset:0 nt
    v_add_f32_dpp v90, v33, v32 row_ror:8 row_mask:0xf bank_mask:0x3
    v_add_f32_dpp v90, v34, v35 row_ror:8 row_mask:0xf bank_mask:0xc
    v_mfma_f32_16x16x32_bf16 v[32:35], a[240:243], v[16:19], 0
    v_mfma_f32_16x16x32_bf16 v[32:35], a[244:247], v[20:23], v[32:35]
    v_add_f32_dpp v91, v37, v36 row_ror:8 row_mask:0xf bank_mask:0x3
    v_add_f32_dpp v91, v38, v39 row_ror:8 row_mask:0xf bank_mask:0xc
    v_mfma_f32_16x16x32_bf16 v[36:39], a[248:251], v[16:19], 0
    v_mfma_f32_16x16x32_bf16 v[36:39], a[252:255], v[20:23], v[36:39]
    s_waitcnt vmcnt(5)
    buffer_load_dwordx4 v[148:151], v3, s[32:35], s57 offen offset:1024 nt
    v_add_f32_dpp v92, v25, v24 row_ror:8 row_mask:0xf bank_mask:0x3
    v_add_f32_dpp v92, v26, v27 row_ror:8 row_mask:0xf bank_mask:0xc
    v_mfma_f32_16x16x32_bf16 v[24:27], a[0:3], v[56:59], 0
    v_mfma_f32_16x16x32_bf16 v[24:27], a[4:7], v[60:63], v[24:27]
    v_add_f32_dpp v93, v29, v28 row_ror:8 row_mask:0xf bank_mask:0x3
    v_add_f32_dpp v93, v30, v31 row_ror:8 row_mask:0xf bank_mask:0xc
    v_mfma_f32_16x16x32_bf16 v[28:31], a[8:11], v[56:59], 0
    v_mfma_f32_16x16x32_bf16 v[28:31], a[12:15], v[60:63], v[28:31]
    v_add_f32_dpp v94, v33, v32 row_ror:8 row_mask:0xf bank_mask:0x3
    v_add_f32_dpp v94, v34, v35 row_ror:8 row_mask:0xf bank_mask:0xc
    v_mfma_f32_16x16x32_bf16 v[32:35], a[16:19], v[56:59], 0
    v_mfma_f32_16x16x32_bf16 v[32:35], a[20:23], v[60:63], v[32:35]
    s_waitcnt vmcnt(5)
    buffer_load_dwordx4 v[152:155], v3, s[32:35], s57 offen offset:2048 nt
    v_add_f32_dpp v95, v37, v36 row_ror:8 row_mask:0xf bank_mask:0x3
    v_add_f32_dpp v95, v38, v39 row_ror:8 row_mask:0xf bank_mask:0xc
    v_mfma_f32_16x16x32_bf16 v[36:39], a[24:27], v[56:59], 0
    v_mfma_f32_16x16x32_bf16 v[36:39], a[28:31], v[60:63], v[36:39]
    v_add_f32_dpp v112, v25, v24 row_ror:8 row_mask:0xf bank_mask:0x3
    v_add_f32_dpp v112, v26, v27 row_ror:8 row_mask:0xf bank_mask:0xc
    v_mfma_f32_16x16x32_bf16 v[24:27], a[32:35], v[56:59], 0
    v_mfma_f32_16x16x32_bf16 v[24:27], a[36:39], v[60:63], v[24:27]
    v_add_f32_dpp v113, v29, v28 row_ror:8 row_mask:0xf bank_mask:0x3
    v_add_f32_dpp v113, v30, v31 row_ror:8 row_mask:0xf bank_mask:0xc
    v_mfma_f32_16x16x32_bf16 v[28:31], a[40:43], v[56:59], 0
    v_mfma_f32_16x16x32_bf16 v[28:31], a[44:47], v[60:63], v[28:31]
    s_waitcnt vmcnt(5)
    buffer_load_dwordx4 v[156:159], v3, s[32:35], s57 offen offset:3072 nt
    s_addk_i32 s57, 0x4000
    v_add_f32_dpp v114, v33, v32 row_ror:8 row_mask:0xf bank_mask:0x3
    v_add_f32_dpp v114, v34, v35 row_ror:8 row_mask:0xf bank_mask:0xc
    v_mfma_f32_16x16x32_bf16 v[32:35], a[48:51], v[56:59], 0
    v_mfma_f32_16x16x32_bf16 v[32:35], a[52:55], v[60:63], v[32:35]
    v_add_f32_dpp v115, v37, v36 row_ror:8 row_mask:0xf bank_mask:0x3
    v_add_f32_dpp v115, v38, v39 row_ror:8 row_mask:0xf bank_mask:0xc
    v_mfma_f32_16x16x32_bf16 v[36:39], a[56:59], v[56:59], 0
    v_mfma_f32_16x16x32_bf16 v[36:39], a[60:63], v[60:63], v[36:39]
    s_waitcnt vmcnt(5)
    buffer_load_dwordx4 v[160:163], v3, s[32:35], s57 offen offset:0 nt
    v_add_f32_dpp v116, v25, v24 row_ror:8 row_mask:0xf bank_mask:0x3
    v_add_f32_dpp v116, v26, v27 row_ror:8 row_mask:0xf bank_mask:0xc
    v_mfma_f32_16x16x32_bf16 v[24:27], a[64:67], v[56:59], 0
    v_mfma_f32_16x16x32_bf16 v[24:27], a[68:71], v[60:63], v[24:27]
    v_add_f32_dpp v117, v29, v28 row_ror:8 row_mask:0xf bank_mask:0x3
    v_add_f32_dpp v117, v30, v31 row_ror:8 row_mask:0xf bank_mask:0xc
    v_mfma_f32_16x16x32_bf16 v[28:31], a[72:75], v[56:59], 0
    v_mfma_f32_16x16x32_bf16 v[28:31], a[76:79], v[60:63], v[28:31]
    v_add_f32_dpp v118, v33, v32 row_ror:8 row_mask:0xf bank_mask:0x3
    v_add_f32_dpp v118, v34, v35 row_ror:8 row_mask:0xf bank_mask:0xc
    v_mfma_f32_16x16x32_bf16 v[32:35], a[80:83], v[56:59], 0
    v_mfma_f32_16x16x32_bf16 v[32:35], a[84:87], v[60:63], v[32:35]
    s_waitcnt vmcnt(5)
    buffer_load_dwordx4 v[164:167], v3, s[32:35], s57 offen offset:1024 nt
    v_add_f32_dpp v119, v37, v36 row_ror:8 row_mask:0xf bank_mask:0x3
    v_add_f32_dpp v119, v38, v39 row_ror:8 row_mask:0xf bank_mask:0xc
    v_mfma_f32_16x16x32_bf16 v[36:39], a[88:91], v[56:59], 0
    v_mfma_f32_16x16x32_bf16 v[36:39], a[92:95], v[60:63], v[36:39]
    v_add_f32_dpp v120, v25, v24 row_ror:8 row_mask:0xf bank_mask:0x3
    v_add_f32_dpp v120, v26, v27 row_ror:8 row_mask:0xf bank_mask:0xc
    v_mfma_f32_16x16x32_bf16 v[24:27], a[96:99], v[56:59], 0
    v_mfma_f32_16x16x32_bf16 v[24:27], a[100:103], v[60:63], v[24:27]
    v_add_f32_dpp v121, v29, v28 row_ror:8 row_mask:0xf bank_mask:0x3
    v_add_f32_dpp v121, v30, v31 row_ror:8 row_mask:0xf bank_mask:0xc
    v_mfma_f32_16x16x32_bf16 v[28:31], a[104:107], v[56:59], 0
    v_mfma_f32_16x16x32_bf16 v[28:31], a[108:111], v[60:63], v[28:31]
    s_waitcnt vmcnt(5)
    buffer_load_dwordx4 v[168:171], v3, s[32:35], s57 offen offset:2048 nt
    v_add_f32_dpp v122, v33, v32 row_ror:8 row_mask:0xf bank_mask:0x3
    v_add_f32_dpp v122, v34, v35 row_ror:8 row_mask:0xf bank_mask:0xc
    v_mfma_f32_16x16x32_bf16 v[32:35], a[112:115], v[56:59], 0
    v_mfma_f32_16x16x32_bf16 v[32:35], a[116:119], v[60:63], v[32:35]
    v_add_f32_dpp v123, v37, v36 row_ror:8 row_mask:0xf bank_mask:0x3
    v_add_f32_dpp v123, v38, v39 row_ror:8 row_mask:0xf bank_mask:0xc
    v_mfma_f32_16x16x32_bf16 v[36:39], a[120:123], v[56:59], 0
    v_mfma_f32_16x16x32_bf16 v[36:39], a[124:127], v[60:63], v[36:39]
    s_waitcnt vmcnt(5)
    buffer_load_dwordx4 v[172:175], v3, s[32:35], s57 offen offset:3072 nt
    s_addk_i32 s57, 0x4000
    v_add_f32_dpp v124, v25, v24 row_ror:8 row_mask:0xf bank_mask:0x3
    v_add_f32_dpp v124, v26, v27 row_ror:8 row_mask:0xf bank_mask:0xc
    v_add_f32_dpp v125, v29, v28 row_ror:8 row_mask:0xf bank_mask:0x3
    v_add_f32_dpp v125, v30, v31 row_ror:8 row_mask:0xf bank_mask:0xc
    v_add_f32_dpp v126, v33, v32 row_ror:8 row_mask:0xf bank_mask:0x3
    v_add_f32_dpp v126, v34, v35 row_ror:8 row_mask:0xf bank_mask:0xc
    v_add_f32_dpp v127, v37, v36 row_ror:8 row_mask:0xf bank_mask:0x3
    v_add_f32_dpp v127, v38, v39 row_ror:8 row_mask:0xf bank_mask:0xc
    v_and_b32 v10, 7, v1
    v_lshlrev_b32 v10, 6, v10
    v_lshl_add_u32 v11, v6, 2, v7
    v_lshl_add_u32 v11, v11, 2, v10
    v_max3_f32 v12, v64, v65, v66
    v_max3_f32 v12, v12, v67, v68
    v_max3_f32 v12, v12, v69, v70
    v_max3_f32 v12, v12, v71, v72
    v_max3_f32 v12, v12, v73, v74
    v_max3_f32 v12, v12, v75, v76
    v_max3_f32 v12, v12, v77, v78
    v_max3_f32 v12, v12, v79, v80
    v_max3_f32 v12, v12, v81, v82
    v_max3_f32 v12, v12, v83, v84
    v_max3_f32 v12, v12, v85, v86
    v_max3_f32 v12, v12, v87, v88
    v_max3_f32 v12, v12, v89, v90
    v_max3_f32 v12, v12, v91, v92
    v_max3_f32 v12, v12, v93, v94
    v_max_f32 v12, v12, v95
    v_max3_f32 v13, v96, v97, v98
    v_max3_f32 v13, v13, v99, v100
    v_max3_f32 v13, v13, v101, v102
    v_max3_f32 v13, v13, v103, v104
    v_max3_f32 v13, v13, v105, v106
    v_max3_f32 v13, v13, v107, v108
    v_max3_f32 v13, v13, v109, v110
    v_max3_f32 v13, v13, v111, v112
    v_max3_f32 v13, v13, v113, v114
    v_max3_f32 v13, v13, v115, v116
    v_max3_f32 v13, v13, v117, v118
    v_max3_f32 v13, v13, v119, v120
    v_max3_f32 v13, v13, v121, v122
    v_max3_f32 v13, v13, v123, v124
    v_max3_f32 v13, v13, v125, v126
    v_max_f32 v13, v13, v127
    v_max_f32_dpp v12, v12, v12 row_ror:8 row_mask:0xf bank_mask:0xf
    s_nop 0
    v_max_f32_dpp v13, v13, v13 row_ror:8 row_mask:0xf bank_mask:0xf
    ds_write_b32 v11, v12 offset:4608
    ds_write_b32 v11, v13 offset:5120
    s_waitcnt vmcnt(5)
    buffer_load_dwordx4 v[176:179], v3, s[32:35], s57 offen offset:0 nt
    s_waitcnt lgkmcnt(0)
    s_barrier
    ds_read_b128 v[24:27], v10 offset:4608
    ds_read_b128 v[28:31], v10 offset:4624
    ds_read_b128 v[32:35], v10 offset:4640
    ds_read_b128 v[36:39], v10 offset:4656
    ds_read_b128 v[40:43], v10 offset:5120
    ds_read_b128 v[44:47], v10 offset:5136
    ds_read_b128 v[48:51], v10 offset:5152
    ds_read_b128 v[52:55], v10 offset:5168
    s_waitcnt vmcnt(5)
    buffer_load_dwordx4 v[180:183], v3, s[32:35], s57 offen offset:1024 nt
    s_waitcnt lgkmcnt(0)
    v_max3_f32 v12, v24, v25, v26
    v_max3_f32 v12, v12, v27, v28
    v_max3_f32 v12, v12, v29, v30
    v_max3_f32 v12, v12, v31, v32
    v_max3_f32 v12, v12, v33, v34
    v_max3_f32 v12, v12, v35, v36
    v_max3_f32 v12, v12, v37, v38
    v_max_f32 v12, v12, v39
    v_mul_f32 v14, s62, v12
    v_mov_b32 v15, 0
    v_max3_f32 v12, v40, v41, v42
    v_max3_f32 v12, v12, v43, v44
    v_max3_f32 v12, v12, v45, v46
    v_max3_f32 v12, v12, v47, v48
    v_max3_f32 v12, v12, v49, v50
    v_max3_f32 v12, v12, v51, v52
    v_max3_f32 v12, v12, v53, v54
    v_max_f32 v12, v12, v55
    v_mul_f32 v16, s62, v12
    v_mov_b32 v17, 0
    v_fma_f32 v64, v64, s62, -v14
    v_fma_f32 v65, v65, s62, -v14
    v_fma_f32 v66, v66, s62, -v14
    v_fma_f32 v67, v67, s62, -v14
    v_exp_f32 v64, v64
    v_exp_f32 v65, v65
    v_exp_f32 v66, v66
    v_exp_f32 v67, v67
    v_add_f32 v15, v15, v64
    v_add_f32 v15, v15, v65
    v_add_f32 v15, v15, v66
    v_add_f32 v15, v15, v67
    v_mov_b32_dpp v24, v64 row_ror:8 row_mask:0xf bank_mask:0xf
    v_mov_b32_dpp v25, v65 row_ror:8 row_mask:0xf bank_mask:0xf
    v_mov_b32_dpp v26, v66 row_ror:8 row_mask:0xf bank_mask:0xf
    v_mov_b32_dpp v27, v67 row_ror:8 row_mask:0xf bank_mask:0xf
    v_cvt_pk_bf16_f32 v64, v64, v24
    v_cvt_pk_bf16_f32 v65, v65, v25
    v_cvt_pk_bf16_f32 v66, v66, v26
    v_cvt_pk_bf16_f32 v67, v67, v27
    v_fma_f32 v68, v68, s62, -v14
    v_fma_f32 v69, v69, s62, -v14
    v_fma_f32 v70, v70, s62, -v14
    v_fma_f32 v71, v71, s62, -v14
    v_exp_f32 v68, v68
    v_exp_f32 v69, v69
    v_exp_f32 v70, v70
    v_exp_f32 v71, v71
    v_add_f32 v15, v15, v68
    v_add_f32 v15, v15, v69
    v_add_f32 v15, v15, v70
    v_add_f32 v15, v15, v71
    v_mov_b32_dpp v24, v68 row_ror:8 row_mask:0xf bank_mask:0xf
    v_mov_b32_dpp v25, v69 row_ror:8 row_mask:0xf bank_mask:0xf
    v_mov_b32_dpp v26, v70 row_ror:8 row_mask:0xf bank_mask:0xf
    v_mov_b32_dpp v27, v71 row_ror:8 row_mask:0xf bank_mask:0xf
    v_cvt_pk_bf16_f32 v68, v68, v24
    v_cvt_pk_bf16_f32 v69, v69, v25
    v_cvt_pk_bf16_f32 v70, v70, v26
    v_cvt_pk_bf16_f32 v71, v71, v27
    s_waitcnt vmcnt(5)
    buffer_load_dwordx4 v[184:187], v3, s[32:35], s57 offen offset:2048 nt
    v_fma_f32 v72, v72, s62, -v14
    v_fma_f32 v73, v73, s62, -v14
    v_fma_f32 v74, v74, s62, -v14
    v_fma_f32 v75, v75, s62, -v14
    v_exp_f32 v72, v72
    v_exp_f32 v73, v73
    v_exp_f32 v74, v74
    v_exp_f32 v75, v75
    v_add_f32 v15, v15, v72
    v_add_f32 v15, v15, v73
    v_add_f32 v15, v15, v74
    v_add_f32 v15, v15, v75
    v_mov_b32_dpp v24, v72 row_ror:8 row_mask:0xf bank_mask:0xf
    v_mov_b32_dpp v25, v73 row_ror:8 row_mask:0xf bank_mask:0xf
    v_mov_b32_dpp v26, v74 row_ror:8 row_mask:0xf bank_mask:0xf
    v_mov_b32_dpp v27, v75 row_ror:8 row_mask:0xf bank_mask:0xf
    v_cvt_pk_bf16_f32 v72, v72, v24
    v_cvt_pk_bf16_f32 v73, v73, v25
    v_cvt_pk_bf16_f32 v74, v74, v26
    v_cvt_pk_bf16_f32 v75, v75, v27
    v_fma_f32 v76, v76, s62, -v14
    v_fma_f32 v77, v77, s62, -v14
    v_fma_f32 v78, v78, s62, -v14
    v_fma_f32 v79, v79, s62, -v14
    v_exp_f32 v76, v76
    v_exp_f32 v77, v77
    v_exp_f32 v78, v78
    v_exp_f32 v79, v79
    v_add_f32 v15, v15, v76
    v_add_f32 v15, v15, v77
    v_add_f32 v15, v15, v78
    v_add_f32 v15, v15, v79
    v_mov_b32_dpp v24, v76 row_ror:8 row_mask:0xf bank_mask:0xf
    v_mov_b32_dpp v25, v77 row_ror:8 row_mask:0xf bank_mask:0xf
    v_mov_b32_dpp v26, v78 row_ror:8 row_mask:0xf bank_mask:0xf
    v_mov_b32_dpp v27, v79 row_ror:8 row_mask:0xf bank_mask:0xf
    v_cvt_pk_bf16_f32 v76, v76, v24
    v_cvt_pk_bf16_f32 v77, v77, v25
    v_cvt_pk_bf16_f32 v78, v78, v26
    v_cvt_pk_bf16_f32 v79, v79, v27
    s_waitcnt vmcnt(5)
    buffer_load_dwordx4 v[188:191], v3, s[32:35], s57 offen offset:3072 nt
    s_addk_i32 s57, 0x4000
    v_fma_f32 v80, v80, s62, -v14
    v_fma_f32 v81, v81, s62, -v14
    v_fma_f32 v82, v82, s62, -v14
    v_fma_f32 v83, v83, s62, -v14
    v_exp_f32 v80, v80
    v_exp_f32 v81, v81
    v_exp_f32 v82, v82
    v_exp_f32 v83, v83
    v_add_f32 v15, v15, v80
    v_add_f32 v15, v15, v81
    v_add_f32 v15, v15, v82
    v_add_f32 v15, v15, v83
    v_mov_b32_dpp v24, v80 row_ror:8 row_mask:0xf bank_mask:0xf
    v_mov_b32_dpp v25, v81 row_ror:8 row_mask:0xf bank_mask:0xf
    v_mov_b32_dpp v26, v82 row_ror:8 row_mask:0xf bank_mask:0xf
    v_mov_b32_dpp v27, v83 row_ror:8 row_mask:0xf bank_mask:0xf
    v_cvt_pk_bf16_f32 v80, v80, v24
    v_cvt_pk_bf16_f32 v81, v81, v25
    v_cvt_pk_bf16_f32 v82, v82, v26
    v_cvt_pk_bf16_f32 v83, v83, v27
    v_fma_f32 v84, v84, s62, -v14
    v_fma_f32 v85, v85, s62, -v14
    v_fma_f32 v86, v86, s62, -v14
    v_fma_f32 v87, v87, s62, -v14
    v_exp_f32 v84, v84
    v_exp_f32 v85, v85
    v_exp_f32 v86, v86
    v_exp_f32 v87, v87
    v_add_f32 v15, v15, v84
    v_add_f32 v15, v15, v85
    v_add_f32 v15, v15, v86
    v_add_f32 v15, v15, v87
    v_mov_b32_dpp v24, v84 row_ror:8 row_mask:0xf bank_mask:0xf
    v_mov_b32_dpp v25, v85 row_ror:8 row_mask:0xf bank_mask:0xf
    v_mov_b32_dpp v26, v86 row_ror:8 row_mask:0xf bank_mask:0xf
    v_mov_b32_dpp v27, v87 row_ror:8 row_mask:0xf bank_mask:0xf
    v_cvt_pk_bf16_f32 v84, v84, v24
    v_cvt_pk_bf16_f32 v85, v85, v25
    v_cvt_pk_bf16_f32 v86, v86, v26
    v_cvt_pk_bf16_f32 v87, v87, v27
    s_waitcnt vmcnt(5)
    buffer_load_dwordx4 v[192:195], v3, s[32:35], s57 offen offset:0 nt
    v_fma_f32 v88, v88, s62, -v14
    v_fma_f32 v89, v89, s62, -v14
    v_fma_f32 v90, v90, s62, -v14
    v_fma_f32 v91, v91, s62, -v14
    v_exp_f32 v88, v88
    v_exp_f32 v89, v89
    v_exp_f32 v90, v90
    v_exp_f32 v91, v91
    v_add_f32 v15, v15, v88
    v_add_f32 v15, v15, v89
    v_add_f32 v15, v15, v90
    v_add_f32 v15, v15, v91
    v_mov_b32_dpp v24, v88 row_ror:8 row_mask:0xf bank_mask:0xf
    v_mov_b32_dpp v25, v89 row_ror:8 row_mask:0xf bank_mask:0xf
    v_mov_b32_dpp v26, v90 row_ror:8 row_mask:0xf bank_mask:0xf
    v_mov_b32_dpp v27, v91 row_ror:8 row_mask:0xf bank_mask:0xf
    v_cvt_pk_bf16_f32 v88, v88, v24
    v_cvt_pk_bf16_f32 v89, v89, v25
    v_cvt_pk_bf16_f32 v90, v90, v26
    v_cvt_pk_bf16_f32 v91, v91, v27
    v_fma_f32 v92, v92, s62, -v14
    v_fma_f32 v93, v93, s62, -v14
    v_fma_f32 v94, v94, s62, -v14
    v_fma_f32 v95, v95, s62, -v14
    v_exp_f32 v92, v92
    v_exp_f32 v93, v93
    v_exp_f32 v94, v94
    v_exp_f32 v95, v95
    v_add_f32 v15, v15, v92
    v_add_f32 v15, v15, v93
    v_add_f32 v15, v15, v94
    v_add_f32 v15, v15, v95
    v_mov_b32_dpp v24, v92 row_ror:8 row_mask:0xf bank_mask:0xf
    v_mov_b32_dpp v25, v93 row_ror:8 row_mask:0xf bank_mask:0xf
    v_mov_b32_dpp v26, v94 row_ror:8 row_mask:0xf bank_mask:0xf
    v_mov_b32_dpp v27, v95 row_ror:8 row_mask:0xf bank_mask:0xf
    v_cvt_pk_bf16_f32 v92, v92, v24
    v_cvt_pk_bf16_f32 v93, v93, v25
    v_cvt_pk_bf16_f32 v94, v94, v26
    v_cvt_pk_bf16_f32 v95, v95, v27
    s_waitcnt vmcnt(5)
    buffer_load_dwordx4 v[196:199], v3, s[32:35], s57 offen offset:1024 nt
    v_fma_f32 v96, v96, s62, -v16
    v_fma_f32 v97, v97, s62, -v16
    v_fma_f32 v98, v98, s62, -v16
    v_fma_f32 v99, v99, s62, -v16
    v_exp_f32 v96, v96
    v_exp_f32 v97, v97
    v_exp_f32 v98, v98
    v_exp_f32 v99, v99
    v_add_f32 v17, v17, v96
    v_add_f32 v17, v17, v97
    v_add_f32 v17, v17, v98
    v_add_f32 v17, v17, v99
    v_mov_b32_dpp v24, v96 row_ror:8 row_mask:0xf bank_mask:0xf
    v_mov_b32_dpp v25, v97 row_ror:8 row_mask:0xf bank_mask:0xf
    v_mov_b32_dpp v26, v98 row_ror:8 row_mask:0xf bank_mask:0xf
    v_mov_b32_dpp v27, v99 row_ror:8 row_mask:0xf bank_mask:0xf
    v_cvt_pk_bf16_f32 v96, v96, v24
    v_cvt_pk_bf16_f32 v97, v97, v25
    v_cvt_pk_bf16_f32 v98, v98, v26
    v_cvt_pk_bf16_f32 v99, v99, v27
    v_fma_f32 v100, v100, s62, -v16
    v_fma_f32 v101, v101, s62, -v16
    v_fma_f32 v102, v102, s62, -v16
    v_fma_f32 v103, v103, s62, -v16
    v_exp_f32 v100, v100
    v_exp_f32 v101, v101
    v_exp_f32 v102, v102
    v_exp_f32 v103, v103
    v_add_f32 v17, v17, v100
    v_add_f32 v17, v17, v101
    v_add_f32 v17, v17, v102
    v_add_f32 v17, v17, v103
    v_mov_b32_dpp v24, v100 row_ror:8 row_mask:0xf bank_mask:0xf
    v_mov_b32_dpp v25, v101 row_ror:8 row_mask:0xf bank_mask:0xf
    v_mov_b32_dpp v26, v102 row_ror:8 row_mask:0xf bank_mask:0xf
    v_mov_b32_dpp v27, v103 row_ror:8 row_mask:0xf bank_mask:0xf
    v_cvt_pk_bf16_f32 v100, v100, v24
    v_cvt_pk_bf16_f32 v101, v101, v25
    v_cvt_pk_bf16_f32 v102, v102, v26
    v_cvt_pk_bf16_f32 v103, v103, v27
    s_waitcnt vmcnt(5)
    buffer_load_dwordx4 v[200:203], v3, s[32:35], s57 offen offset:2048 nt
    v_fma_f32 v104, v104, s62, -v16
    v_fma_f32 v105, v105, s62, -v16
    v_fma_f32 v106, v106, s62, -v16
    v_fma_f32 v107, v107, s62, -v16
    v_exp_f32 v104, v104
    v_exp_f32 v105, v105
    v_exp_f32 v106, v106
    v_exp_f32 v107, v107
    v_add_f32 v17, v17, v104
    v_add_f32 v17, v17, v105
    v_add_f32 v17, v17, v106
    v_add_f32 v17, v17, v107
    v_mov_b32_dpp v24, v104 row_ror:8 row_mask:0xf bank_mask:0xf
    v_mov_b32_dpp v25, v105 row_ror:8 row_mask:0xf bank_mask:0xf
    v_mov_b32_dpp v26, v106 row_ror:8 row_mask:0xf bank_mask:0xf
    v_mov_b32_dpp v27, v107 row_ror:8 row_mask:0xf bank_mask:0xf
    v_cvt_pk_bf16_f32 v104, v104, v24
    v_cvt_pk_bf16_f32 v105, v105, v25
    v_cvt_pk_bf16_f32 v106, v106, v26
    v_cvt_pk_bf16_f32 v107, v107, v27
    v_fma_f32 v108, v108, s62, -v16
    v_fma_f32 v109, v109, s62, -v16
    v_fma_f32 v110, v110, s62, -v16
    v_fma_f32 v111, v111, s62, -v16
    v_exp_f32 v108, v108
    v_exp_f32 v109, v109
    v_exp_f32 v110, v110
    v_exp_f32 v111, v111
    v_add_f32 v17, v17, v108
    v_add_f32 v17, v17, v109
    v_add_f32 v17, v17, v110
    v_add_f32 v17, v17, v111
    v_mov_b32_dpp v24, v108 row_ror:8 row_mask:0xf bank_mask:0xf
    v_mov_b32_dpp v25, v109 row_ror:8 row_mask:0xf bank_mask:0xf
    v_mov_b32_dpp v26, v110 row_ror:8 row_mask:0xf bank_mask:0xf
    v_mov_b32_dpp v27, v111 row_ror:8 row_mask:0xf bank_mask:0xf
    v_cvt_pk_bf16_f32 v108, v108, v24
    v_cvt_pk_bf16_f32 v109, v109, v25
    v_cvt_pk_bf16_f32 v110, v110, v26
    v_cvt_pk_bf16_f32 v111, v111, v27
    s_waitcnt vmcnt(5)
    buffer_load_dwordx4 v[204:207], v3, s[32:35], s57 offen offset:3072 nt
    s_addk_i32 s57, 0x4000
    v_fma_f32 v112, v112, s62, -v16
    v_fma_f32 v113, v113, s62, -v16
    v_fma_f32 v114, v114, s62, -v16
    v_fma_f32 v115, v115, s62, -v16
    v_exp_f32 v112, v112
    v_exp_f32 v113, v113
    v_exp_f32 v114, v114
    v_exp_f32 v115, v115
    v_add_f32 v17, v17, v112
    v_add_f32 v17, v17, v113
    v_add_f32 v17, v17, v114
    v_add_f32 v17, v17, v115
    v_mov_b32_dpp v24, v112 row_ror:8 row_mask:0xf bank_mask:0xf
    v_mov_b32_dpp v25, v113 row_ror:8 row_mask:0xf bank_mask:0xf
    v_mov_b32_dpp v26, v114 row_ror:8 row_mask:0xf bank_mask:0xf
    v_mov_b32_dpp v27, v115 row_ror:8 row_mask:0xf bank_mask:0xf
    v_cvt_pk_bf16_f32 v112, v112, v24
    v_cvt_pk_bf16_f32 v113, v113, v25
    v_cvt_pk_bf16_f32 v114, v114, v26
    v_cvt_pk_bf16_f32 v115, v115, v27
    v_fma_f32 v116, v116, s62, -v16
    v_fma_f32 v117, v117, s62, -v16
    v_fma_f32 v118, v118, s62, -v16
    v_fma_f32 v119, v119, s62, -v16
    v_exp_f32 v116, v116
    v_exp_f32 v117, v117
    v_exp_f32 v118, v118
    v_exp_f32 v119, v119
    v_add_f32 v17, v17, v116
    v_add_f32 v17, v17, v117
    v_add_f32 v17, v17, v118
    v_add_f32 v17, v17, v119
    v_mov_b32_dpp v24, v116 row_ror:8 row_mask:0xf bank_mask:0xf
    v_mov_b32_dpp v25, v117 row_ror:8 row_mask:0xf bank_mask:0xf
    v_mov_b32_dpp v26, v118 row_ror:8 row_mask:0xf bank_mask:0xf
    v_mov_b32_dpp v27, v119 row_ror:8 row_mask:0xf bank_mask:0xf
    v_cvt_pk_bf16_f32 v116, v116, v24
    v_cvt_pk_bf16_f32 v117, v117, v25
    v_cvt_pk_bf16_f32 v118, v118, v26
    v_cvt_pk_bf16_f32 v119, v119, v27
    s_waitcnt vmcnt(5)
    buffer_load_dwordx4 v[208:211], v3, s[32:35], s57 offen offset:0 nt
    v_fma_f32 v120, v120, s62, -v16
    v_fma_f32 v121, v121, s62, -v16
    v_fma_f32 v122, v122, s62, -v16
    v_fma_f32 v123, v123, s62, -v16
    v_exp_f32 v120, v120
    v_exp_f32 v121, v121
    v_exp_f32 v122, v122
    v_exp_f32 v123, v123
    v_add_f32 v17, v17, v120
    v_add_f32 v17, v17, v121
    v_add_f32 v17, v17, v122
    v_add_f32 v17, v17, v123
    v_mov_b32_dpp v24, v120 row_ror:8 row_mask:0xf bank_mask:0xf
    v_mov_b32_dpp v25, v121 row_ror:8 row_mask:0xf bank_mask:0xf
    v_mov_b32_dpp v26, v122 row_ror:8 row_mask:0xf bank_mask:0xf
    v_mov_b32_dpp v27, v123 row_ror:8 row_mask:0xf bank_mask:0xf
    v_cvt_pk_bf16_f32 v120, v120, v24
    v_cvt_pk_bf16_f32 v121, v121, v25
    v_cvt_pk_bf16_f32 v122, v122, v26
    v_cvt_pk_bf16_f32 v123, v123, v27
    v_fma_f32 v124, v124, s62, -v16
    v_fma_f32 v125, v125, s62, -v16
    v_fma_f32 v126, v126, s62, -v16
    v_fma_f32 v127, v127, s62, -v16
    v_exp_f32 v124, v124
    v_exp_f32 v125, v125
    v_exp_f32 v126, v126
    v_exp_f32 v127, v127
    v_add_f32 v17, v17, v124
    v_add_f32 v17, v17, v125
    v_add_f32 v17, v17, v126
    v_add_f32 v17, v17, v127
    v_mov_b32_dpp v24, v124 row_ror:8 row_mask:0xf bank_mask:0xf
    v_mov_b32_dpp v25, v125 row_ror:8 row_mask:0xf bank_mask:0xf
    v_mov_b32_dpp v26, v126 row_ror:8 row_mask:0xf bank_mask:0xf
    v_mov_b32_dpp v27, v127 row_ror:8 row_mask:0xf bank_mask:0xf
    v_cvt_pk_bf16_f32 v124, v124, v24
    v_cvt_pk_bf16_f32 v125, v125, v25
    v_cvt_pk_bf16_f32 v126, v126, v26
    v_cvt_pk_bf16_f32 v127, v127, v27
    s_waitcnt vmcnt(5)
    buffer_load_dwordx4 v[212:215], v3, s[32:35], s57 offen offset:1024 nt
    v_add_f32_dpp v15, v15, v15 row_ror:8 row_mask:0xf bank_mask:0xf
    v_add_f32_dpp v17, v17, v17 row_ror:8 row_mask:0xf bank_mask:0xf
    ds_write_b32 v11, v15 offset:5632
    ds_write_b32 v11, v17 offset:6144
    s_waitcnt vmcnt(5)
    buffer_load_dwordx4 v[216:219], v3, s[32:35], s57 offen offset:2048 nt
    s_waitcnt vmcnt(5)
    buffer_load_dwordx4 v[220:223], v3, s[32:35], s57 offen offset:3072 nt
    s_addk_i32 s57, 0x4000
    s_waitcnt lgkmcnt(0)
    s_barrier
    s_cmp_lg_u32 s26, 1
    s_cbranch_scc1 L_noml
    ds_read_b128 v[24:27], v10 offset:5632
    ds_read_b128 v[28:31], v10 offset:5648
    ds_read_b128 v[32:35], v10 offset:5664
    ds_read_b128 v[36:39], v10 offset:5680
    ds_read_b128 v[40:43], v10 offset:6144
    ds_read_b128 v[44:47], v10 offset:6160
    ds_read_b128 v[48:51], v10 offset:6176
    ds_read_b128 v[52:55], v10 offset:6192
    v_lshlrev_b32 v12, 3, v1
    s_waitcnt lgkmcnt(0)
    v_add_f32 v24, v24, v32
    v_add_f32 v25, v25, v33
    v_add_f32 v26, v26, v34
    v_add_f32 v27, v27, v35
    v_add_f32 v28, v28, v36
    v_add_f32 v29, v29, v37
    v_add_f32 v30, v30, v38
    v_add_f32 v31, v31, v39
    v_add_f32 v24, v24, v28
    v_add_f32 v25, v25, v29
    v_add_f32 v26, v26, v30
    v_add_f32 v27, v27, v31
    v_add_f32 v24, v24, v26
    v_add_f32 v25, v25, v27
    v_add_f32 v24, v24, v25
    v_mov_b32 v15, v24
    v_add_f32 v40, v40, v48
    v_add_f32 v41, v41, v49
    v_add_f32 v42, v42, v50
    v_add_f32 v43, v43, v51
    v_add_f32 v44, v44, v52
    v_add_f32 v45, v45, v53
    v_add_f32 v46, v46, v54
    v_add_f32 v47, v47, v55
    v_add_f32 v40, v40, v44
    v_add_f32 v41, v41, v45
    v_add_f32 v42, v42, v46
    v_add_f32 v43, v43, v47
    v_add_f32 v40, v40, v42
    v_add_f32 v41, v41, v43
    v_add_f32 v40, v40, v41
    v_mov_b32 v17, v40
    s_mov_b64 exec, 0xff
    buffer_store_dwordx2 v[14:15], v12, s[48:51], s76 offen offset:0 sc1
    buffer_store_dwordx2 v[16:17], v12, s[48:51], s76 offen offset:64 sc1
    s_mov_b64 exec, -1
L_noml:
    v_perm_b32 v40, v132, v128, s60
    v_perm_b32 v41, v140, v136, s60
    v_perm_b32 v42, v148, v144, s60
    v_perm_b32 v43, v156, v152, s60
    s_waitcnt vmcnt(5)
    buffer_load_dwordx4 v[224:227], v3, s[32:35], s57 offen offset:0 nt
    v_perm_b32 v44, v132, v128, s61
    v_perm_b32 v45, v140, v136, s61
    v_perm_b32 v46, v148, v144, s61
    v_perm_b32 v47, v156, v152, s61
    s_waitcnt vmcnt(5)
    buffer_load_dwordx4 v[228:231], v3, s[32:35], s57 offen offset:1024 nt
    v_perm_b32 v48, v133, v129, s60
    v_perm_b32 v49, v141, v137, s60
    v_perm_b32 v50, v149, v145, s60
    v_perm_b32 v51, v157, v153, s60
    s_waitcnt vmcnt(5)
    buffer_load_dwordx4 v[232:235], v3, s[32:35], s57 offen offset:2048 nt
    v_perm_b32 v52, v133, v129, s61
    v_perm_b32 v53, v141, v137, s61
    v_perm_b32 v54, v149, v145, s61
    v_perm_b32 v55, v157, v153, s61
    s_waitcnt vmcnt(5)
    buffer_load_dwordx4 v[236:239], v3, s[32:35], s57 offen offset:3072 nt
    s_addk_i32 s57, 0x4000
    v_mfma_f32_16x16x32_bf16 a[0:3], v[40:43], v[64:67], 0
    v_mfma_f32_16x16x32_bf16 a[4:7], v[44:47], v[64:67], 0
    v_perm_b32 v40, v134, v130, s60
    v_perm_b32 v41, v142, v138, s60
    v_perm_b32 v42, v150, v146, s60
    v_perm_b32 v43, v158, v154, s60
    s_waitcnt vmcnt(5)
    buffer_load_dwordx4 v[240:243], v3, s[32:35], s57 offen offset:0 nt
    v_perm_b32 v44, v134, v130, s61
    v_perm_b32 v45, v142, v138, s61
    v_perm_b32 v46, v150, v146, s61
    v_perm_b32 v47, v158, v154, s61
    s_waitcnt vmcnt(5)
    buffer_load_dwordx4 v[244:247], v3, s[32:35], s57 offen offset:1024 nt
    v_mfma_f32_16x16x32_bf16 a[8:11], v[48:51], v[64:67], 0
    v_mfma_f32_16x16x32_bf16 a[12:15], v[52:55], v[64:67], 0
    v_perm_b32 v48, v135, v131, s60
    v_perm_b32 v49, v143, v139, s60
    v_perm_b32 v50, v151, v147, s60
    v_perm_b32 v51, v159, v155, s60
    s_waitcnt vmcnt(5)
    buffer_load_dwordx4 v[248:251], v3, s[32:35], s57 offen offset:2048 nt
    v_perm_b32 v52, v135, v131, s61
    v_perm_b32 v53, v143, v139, s61
    v_perm_b32 v54, v151, v147, s61
    v_perm_b32 v55, v159, v155, s61
    s_waitcnt vmcnt(5)
    buffer_load_dwordx4 v[252:255], v3, s[32:35], s57 offen offset:3072 nt
    s_addk_i32 s57, 0x4000
    v_mfma_f32_16x16x32_bf16 a[16:19], v[40:43], v[64:67], 0
    v_mfma_f32_16x16x32_bf16 a[20:23], v[44:47], v[64:67], 0
    v_mfma_f32_16x16x32_bf16 a[24:27], v[48:51], v[64:67], 0
    v_mfma_f32_16x16x32_bf16 a[28:31], v[52:55], v[64:67], 0
    v_perm_b32 v40, v164, v160, s60
    v_perm_b32 v41, v172, v168, s60
    v_perm_b32 v42, v180, v176, s60
    v_perm_b32 v43, v188, v184, s60
    s_waitcnt vmcnt(5)
    buffer_load_dwordx4 v[128:131], v3, s[32:35], s57 offen offset:0 nt
    v_perm_b32 v44, v164, v160, s61
    v_perm_b32 v45, v172, v168, s61
    v_perm_b32 v46, v180, v176, s61
    v_perm_b32 v47, v188, v184, s61
    s_waitcnt vmcnt(5)
    buffer_load_dwordx4 v[132:135], v3, s[32:35], s57 offen offset:1024 nt
    v_perm_b32 v48, v165, v161, s60
    v_perm_b32 v49, v173, v169, s60
    v_perm_b32 v50, v181, v177, s60
    v_perm_b32 v51, v189, v185, s60
    s_waitcnt vmcnt(5)
    buffer_load_dwordx4 v[136:139], v3, s[32:35], s57 offen offset:2048 nt
    v_perm_b32 v52, v165, v161, s61
    v_perm_b32 v53, v173, v169, s61
    v_perm_b32 v54, v181, v177, s61
    v_perm_b32 v55, v189, v185, s61
    s_waitcnt vmcnt(5)
    buffer_load_dwordx4 v[140:143], v3, s[32:35], s57 offen offset:3072 nt
    s_addk_i32 s57, 0x4000
    v_mfma_f32_16x16x32_bf16 a[0:3], v[40:43], v[68:71], a[0:3]
    v_mfma_f32_16x16x32_bf16 a[4:7], v[44:47], v[68:71], a[4:7]
    v_perm_b32 v40, v166, v162, s60
    v_perm_b32 v41, v174, v170, s60
    v_perm_b32 v42, v182, v178, s60
    v_perm_b32 v43, v190, v186, s60
    s_waitcnt vmcnt(5)
    buffer_load_dwordx4 v[144:147], v3, s[32:35], s57 offen offset:0 nt
    v_perm_b32 v44, v166, v162, s61
    v_perm_b32 v45, v174, v170, s61
    v_perm_b32 v46, v182, v178, s61
    v_perm_b32 v47, v190, v186, s61
    s_waitcnt vmcnt(5)
    buffer_load_dwordx4 v[148:151], v3, s[32:35], s57 offen offset:1024 nt
    v_mfma_f32_16x16x32_bf16 a[8:11], v[48:51], v[68:71], a[8:11]
    v_mfma_f32_16x16x32_bf16 a[12:15], v[52:55], v[68:71], a[12:15]
    v_perm_b32 v48, v167, v163, s60
    v_perm_b32 v49, v175, v171, s60
    v_perm_b32 v50, v183, v179, s60
    v_perm_b32 v51, v191, v187, s60
    s_waitcnt vmcnt(5)
    buffer_load_dwordx4 v[152:155], v3, s[32:35], s57 offen offset:2048 nt
    v_perm_b32 v52, v167, v163, s61
    v_perm_b32 v53, v175, v171, s61
    v_perm_b32 v54, v183, v179, s61
    v_perm_b32 v55, v191, v187, s61
    s_waitcnt vmcnt(5)
    buffer_load_dwordx4 v[156:159], v3, s[32:35], s57 offen offset:3072 nt
    s_addk_i32 s57, 0x4000
    v_mfma_f32_16x16x32_bf16 a[16:19], v[40:43], v[68:71], a[16:19]
    v_mfma_f32_16x16x32_bf16 a[20:23], v[44:47], v[68:71], a[20:23]
    v_mfma_f32_16x16x32_bf16 a[24:27], v[48:51], v[68:71], a[24:27]
    v_mfma_f32_16x16x32_bf16 a[28:31], v[52:55], v[68:71], a[28:31]
    v_lshrrev_b32 v9, 5, v1
    v_lshlrev_b32 v9, 7, v9
    v_and_b32 v12, 31, v1
    v_add_u32 v9, v9, v12
    s_lshl_b32 s4, s59, 5
    v_add_u32 v9, s4, v9
    v_lshlrev_b32 v9, 7, v9
    v_and_b32 v12, 1, v6
    v_lshrrev_b32 v8, 3, v1
    v_lshl_add_u32 v14, v12, 5, v8
    v_lshlrev_b32 v14, 2, v14
    v_lshl_add_u32 v8, v12, 7, v8
    v_add_u32 v8, s4, v8
    v_lshlrev_b32 v8, 12, v8
    v_lshrrev_b32 v12, 1, v6
    v_lshl_or_b32 v8, v12, 7, v8
    v_and_b32 v12, 7, v1
    v_lshl_or_b32 v8, v12, 4, v8
    v_lshlrev_b32 v16, 6, v6
    v_lshl_or_b32 v16, v12, 3, v16
    v_bfe_u32 v12, v1, 4, 1
    v_lshl_or_b32 v16, v12, 2, v16
    v_lshrrev_b32 v12, 5, v1
    v_lshl_or_b32 v16, v12, 1, v16
    v_and_b32 v15, 1, v1
    v_lshlrev_b32 v15, 6, v15
    v_lshl_or_b32 v15, v7, 4, v15
    v_add_u32 v2, 0x10000, v4
    s_lshr_b32 s4, s27, 2
    s_lshl_b32 s4, s4, 3
    s_lshl_b32 s5, s3, 6
    s_add_u32 s4, s4, s5
    s_add_u32 s77, s4, 262144
    s_lshr_b32 s4, s27, 1
    s_lshl_b32 s4, s4, 8
    s_lshl_b32 s5, s3, 20
    s_add_u32 s4, s4, s5
    s_add_u32 s8, s4, 2097152
    s_add_u32 s9, s8, 0x8000
    s_add_u32 s10, s9, 0x8000
    s_add_u32 s11, s10, 0x8000
    v_and_b32 v19, 3, v1
    v_lshlrev_b32 v19, 2, v19
    s_lshl_b32 s4, s3, 7
    v_add_u32 v19, s4, v19
    v_perm_b32 v40, v196, v192, s60
    v_perm_b32 v41, v204, v200, s60
    v_perm_b32 v42, v212, v208, s60
    v_perm_b32 v43, v220, v216, s60
    s_waitcnt vmcnt(5)
    buffer_load_dwordx4 v[160:163], v3, s[32:35], s57 offen offset:0 nt
    v_perm_b32 v44, v196, v192, s61
    v_perm_b32 v45, v204, v200, s61
    v_perm_b32 v46, v212, v208, s61
    v_perm_b32 v47, v220, v216, s61
    s_waitcnt vmcnt(5)
    buffer_load_dwordx4 v[164:167], v3, s[32:35], s57 offen offset:1024 nt
    v_perm_b32 v48, v197, v193, s60
    v_perm_b32 v49, v205, v201, s60
    v_perm_b32 v50, v213, v209, s60
    v_perm_b32 v51, v221, v217, s60
    s_waitcnt vmcnt(5)
    buffer_load_dwordx4 v[168:171], v3, s[32:35], s57 offen offset:2048 nt
    v_perm_b32 v52, v197, v193, s61
    v_perm_b32 v53, v205, v201, s61
    v_perm_b32 v54, v213, v209, s61
    v_perm_b32 v55, v221, v217, s61
    s_waitcnt vmcnt(5)
    buffer_load_dwordx4 v[172:175], v3, s[32:35], s57 offen offset:3072 nt
    s_addk_i32 s57, 0x4000
    v_mfma_f32_16x16x32_bf16 a[0:3], v[40:43], v[72:75], a[0:3]
    v_mfma_f32_16x16x32_bf16 a[4:7], v[44:47], v[72:75], a[4:7]
    v_perm_b32 v40, v198, v194, s60
    v_perm_b32 v41, v206, v202, s60
    v_perm_b32 v42, v214, v210, s60
    v_perm_b32 v43, v222, v218, s60
    s_waitcnt vmcnt(5)
    buffer_load_dwordx4 v[176:179], v3, s[32:35], s57 offen offset:0 nt
    v_perm_b32 v44, v198, v194, s61
    v_perm_b32 v45, v206, v202, s61
    v_perm_b32 v46, v214, v210, s61
    v_perm_b32 v47, v222, v218, s61
    s_waitcnt vmcnt(5)
    buffer_load_dwordx4 v[180:183], v3, s[32:35], s57 offen offset:1024 nt
    v_mfma_f32_16x16x32_bf16 a[8:11], v[48:51], v[72:75], a[8:11]
    v_mfma_f32_16x16x32_bf16 a[12:15], v[52:55], v[72:75], a[12:15]
    v_perm_b32 v48, v199, v195, s60
    v_perm_b32 v49, v207, v203, s60
    v_perm_b32 v50, v215, v211, s60
    v_perm_b32 v51, v223, v219, s60
    s_waitcnt vmcnt(5)
    buffer_load_dwordx4 v[184:187], v3, s[32:35], s57 offen offset:2048 nt
    v_perm_b32 v52, v199, v195, s61
    v_perm_b32 v53, v207, v203, s61
    v_perm_b32 v54, v215, v211, s61
    v_perm_b32 v55, v223, v219, s61
    s_waitcnt vmcnt(5)
    buffer_load_dwordx4 v[188:191], v3, s[32:35], s57 offen offset:3072 nt
    s_addk_i32 s57, 0x4000
    v_mfma_f32_16x16x32_bf16 a[16:19], v[40:43], v[72:75], a[16:19]
    v_mfma_f32_16x16x32_bf16 a[20:23], v[44:47], v[72:75], a[20:23]
    v_mfma_f32_16x16x32_bf16 a[24:27], v[48:51], v[72:75], a[24:27]
    v_mfma_f32_16x16x32_bf16 a[28:31], v[52:55], v[72:75], a[28:31]
    v_and_b32 v10, 7, v1
    v_mul_u32_u24 v10, 528, v10
    v_lshl_add_u32 v10, v7, 7, v10
    v_mul_u32_u24 v11, 4224, v6
    v_add_u32 v10, v10, v11
    v_lshrrev_b32 v11, 5, v0
    v_mul_u32_u24 v11, 528, v11
    v_and_b32 v12, 31, v0
    v_lshl_add_u32 v11, v12, 4, v11
    v_lshlrev_b32 v13, 4, v0
    v_lshlrev_b32 v5, 10, v6
    v_lshl_or_b32 v5, v7, 5, v5
    v_and_b32 v12, 1, v1
    v_lshl_or_b32 v5, v12, 4, v5
    v_bfe_u32 v12, v1, 1, 3
    v_lshl_or_b32 v5, v12, 28, v5
    v_perm_b32 v40, v228, v224, s60
    v_perm_b32 v41, v236, v232, s60
    v_perm_b32 v42, v244, v240, s60
    v_perm_b32 v43, v252, v248, s60
    s_waitcnt vmcnt(5)
    buffer_load_dwordx4 v[192:195], v3, s[32:35], s57 offen offset:0 nt
    v_perm_b32 v44, v228, v224, s61
    v_perm_b32 v45, v236, v232, s61
    v_perm_b32 v46, v244, v240, s61
    v_perm_b32 v47, v252, v248, s61
    s_waitcnt vmcnt(5)
    buffer_load_dwordx4 v[196:199], v3, s[32:35], s57 offen offset:1024 nt
    v_perm_b32 v48, v229, v225, s60
    v_perm_b32 v49, v237, v233, s60
    v_perm_b32 v50, v245, v241, s60
    v_perm_b32 v51, v253, v249, s60
    s_waitcnt vmcnt(5)
    buffer_load_dwordx4 v[200:203], v3, s[32:35], s57 offen offset:2048 nt
    v_perm_b32 v52, v229, v225, s61
    v_perm_b32 v53, v237, v233, s61
    v_perm_b32 v54, v245, v241, s61
    v_perm_b32 v55, v253, v249, s61
    s_waitcnt vmcnt(5)
    buffer_load_dwordx4 v[204:207], v3, s[32:35], s57 offen offset:3072 nt
    s_addk_i32 s57, 0x4000
    v_mfma_f32_16x16x32_bf16 a[0:3], v[40:43], v[76:79], a[0:3]
    v_mfma_f32_16x16x32_bf16 a[4:7], v[44:47], v[76:79], a[4:7]
    v_perm_b32 v40, v230, v226, s60
    v_perm_b32 v41, v238, v234, s60
    v_perm_b32 v42, v246, v242, s60
    v_perm_b32 v43, v254, v250, s60
    s_waitcnt vmcnt(5)
    buffer_load_dwordx4 v[208:211], v3, s[32:35], s57 offen offset:0 nt
    v_perm_b32 v44, v230, v226, s61
    v_perm_b32 v45, v238, v234, s61
    v_perm_b32 v46, v246, v242, s61
    v_perm_b32 v47, v254, v250, s61
    s_waitcnt vmcnt(5)
    buffer_load_dwordx4 v[212:215], v3, s[32:35], s57 offen offset:1024 nt
    v_mfma_f32_16x16x32_bf16 a[8:11], v[48:51], v[76:79], a[8:11]
    v_mfma_f32_16x16x32_bf16 a[12:15], v[52:55], v[76:79], a[12:15]
    v_perm_b32 v48, v231, v227, s60
    v_perm_b32 v49, v239, v235, s60
    v_perm_b32 v50, v247, v243, s60
    v_perm_b32 v51, v255, v251, s60
    s_waitcnt vmcnt(5)
    buffer_load_dwordx4 v[216:219], v3, s[32:35], s57 offen offset:2048 nt
    v_perm_b32 v52, v231, v227, s61
    v_perm_b32 v53, v239, v235, s61
    v_perm_b32 v54, v247, v243, s61
    v_perm_b32 v55, v255, v251, s61
    s_waitcnt vmcnt(5)
    buffer_load_dwordx4 v[220:223], v3, s[32:35], s57 offen offset:3072 nt
    s_addk_i32 s57, 0x4000
    v_mfma_f32_16x16x32_bf16 a[16:19], v[40:43], v[76:79], a[16:19]
    v_mfma_f32_16x16x32_bf16 a[20:23], v[44:47], v[76:79], a[20:23]
    v_mfma_f32_16x16x32_bf16 a[24:27], v[48:51], v[76:79], a[24:27]
    v_mfma_f32_16x16x32_bf16 a[28:31], v[52:55], v[76:79], a[28:31]
    v_perm_b32 v40, v132, v128, s60
    v_perm_b32 v41, v140, v136, s60
    v_perm_b32 v42, v148, v144, s60
    v_perm_b32 v43, v156, v152, s60
    s_waitcnt vmcnt(5)
    buffer_load_dwordx4 v[224:227], v3, s[32:35], s57 offen offset:0 nt
    v_perm_b32 v44, v132, v128, s61
    v_perm_b32 v45, v140, v136, s61
    v_perm_b32 v46, v148, v144, s61
    v_perm_b32 v47, v156, v152, s61
    s_waitcnt vmcnt(5)
    buffer_load_dwordx4 v[228:231], v3, s[32:35], s57 offen offset:1024 nt
    v_perm_b32 v48, v133, v129, s60
    v_perm_b32 v49, v141, v137, s60
    v_perm_b32 v50, v149, v145, s60
    v_perm_b32 v51, v157, v153, s60
    s_waitcnt vmcnt(5)
    buffer_load_dwordx4 v[232:235], v3, s[32:35], s57 offen offset:2048 nt
    v_perm_b32 v52, v133, v129, s61
    v_perm_b32 v53, v141, v137, s61
    v_perm_b32 v54, v149, v145, s61
    v_perm_b32 v55, v157, v153, s61
    s_waitcnt vmcnt(5)
    buffer_load_dwordx4 v[236:239], v3, s[32:35], s57 offen offset:3072 nt
    s_addk_i32 s57, 0x4000
    v_mfma_f32_16x16x32_bf16 a[0:3], v[40:43], v[80:83], a[0:3]
    v_mfma_f32_16x16x32_bf16 a[4:7], v[44:47], v[80:83], a[4:7]
    v_perm_b32 v40, v134, v130, s60
    v_perm_b32 v41, v142, v138, s60
    v_perm_b32 v42, v150, v146, s60
    v_perm_b32 v43, v158, v154, s60
    s_waitcnt vmcnt(5)
    buffer_load_dwordx4 v[240:243], v3, s[32:35], s57 offen offset:0 nt
    v_perm_b32 v44, v134, v130, s61
    v_perm_b32 v45, v142, v138, s61
    v_perm_b32 v46, v150, v146, s61
    v_perm_b32 v47, v158, v154, s61
    s_waitcnt vmcnt(5)
    buffer_load_dwordx4 v[244:247], v3, s[32:35], s57 offen offset:1024 nt
    v_mfma_f32_16x16x32_bf16 a[8:11], v[48:51], v[80:83], a[8:11]
    v_mfma_f32_16x16x32_bf16 a[12:15], v[52:55], v[80:83], a[12:15]
    v_perm_b32 v48, v135, v131, s60
    v_perm_b32 v49, v143, v139, s60
    v_perm_b32 v50, v151, v147, s60
    v_perm_b32 v51, v159, v155, s60
    s_waitcnt vmcnt(5)
    buffer_load_dwordx4 v[248:251], v3, s[32:35], s57 offen offset:2048 nt
    v_perm_b32 v52, v135, v131, s61
    v_perm_b32 v53, v143, v139, s61
    v_perm_b32 v54, v151, v147, s61
    v_perm_b32 v55, v159, v155, s61
    s_waitcnt vmcnt(5)
    buffer_load_dwordx4 v[252:255], v3, s[32:35], s57 offen offset:3072 nt
    s_lshl_b32 s57, s26, 12
    v_mfma_f32_16x16x32_bf16 a[16:19], v[40:43], v[80:83], a[16:19]
    v_mfma_f32_16x16x32_bf16 a[20:23], v[44:47], v[80:83], a[20:23]
    v_mfma_f32_16x16x32_bf16 a[24:27], v[48:51], v[80:83], a[24:27]
    v_mfma_f32_16x16x32_bf16 a[28:31], v[52:55], v[80:83], a[28:31]
    v_perm_b32 v40, v164, v160, s60
    v_perm_b32 v41, v172, v168, s60
    v_perm_b32 v42, v180, v176, s60
    v_perm_b32 v43, v188, v184, s60
    s_waitcnt vmcnt(5)
    buffer_load_dwordx4 v[128:131], v3, s[44:47], s57 offen offset:0 nt
    v_perm_b32 v44, v164, v160, s61
    v_perm_b32 v45, v172, v168, s61
    v_perm_b32 v46, v180, v176, s61
    v_perm_b32 v47, v188, v184, s61
    s_waitcnt vmcnt(5)
    buffer_load_dwordx4 v[132:135], v3, s[44:47], s57 offen offset:1024 nt
    v_perm_b32 v48, v165, v161, s60
    v_perm_b32 v49, v173, v169, s60
    v_perm_b32 v50, v181, v177, s60
    v_perm_b32 v51, v189, v185, s60
    s_waitcnt vmcnt(5)
    buffer_load_dwordx4 v[136:139], v3, s[44:47], s57 offen offset:2048 nt
    v_perm_b32 v52, v165, v161, s61
    v_perm_b32 v53, v173, v169, s61
    v_perm_b32 v54, v181, v177, s61
    v_perm_b32 v55, v189, v185, s61
    s_waitcnt vmcnt(5)
    buffer_load_dwordx4 v[140:143], v3, s[44:47], s57 offen offset:3072 nt
    s_addk_i32 s57, 0x4000
    v_mfma_f32_16x16x32_bf16 a[0:3], v[40:43], v[84:87], a[0:3]
    v_mfma_f32_16x16x32_bf16 a[4:7], v[44:47], v[84:87], a[4:7]
    v_perm_b32 v40, v166, v162, s60
    v_perm_b32 v41, v174, v170, s60
    v_perm_b32 v42, v182, v178, s60
    v_perm_b32 v43, v190, v186, s60
    s_waitcnt vmcnt(5)
    buffer_load_dwordx4 v[144:147], v3, s[44:47], s57 offen offset:0 nt
    v_perm_b32 v44, v166, v162, s61
    v_perm_b32 v45, v174, v170, s61
    v_perm_b32 v46, v182, v178, s61
    v_perm_b32 v47, v190, v186, s61
    s_waitcnt vmcnt(5)
    buffer_load_dwordx4 v[148:151], v3, s[44:47], s57 offen offset:1024 nt
    v_mfma_f32_16x16x32_bf16 a[8:11], v[48:51], v[84:87], a[8:11]
    v_mfma_f32_16x16x32_bf16 a[12:15], v[52:55], v[84:87], a[12:15]
    v_perm_b32 v48, v167, v163, s60
    v_perm_b32 v49, v175, v171, s60
    v_perm_b32 v50, v183, v179, s60
    v_perm_b32 v51, v191, v187, s60
    s_waitcnt vmcnt(5)
    buffer_load_dwordx4 v[152:155], v3, s[44:47], s57 offen offset:2048 nt
    v_perm_b32 v52, v167, v163, s61
    v_perm_b32 v53, v175, v171, s61
    v_perm_b32 v54, v183, v179, s61
    v_perm_b32 v55, v191, v187, s61
    s_waitcnt vmcnt(5)
    buffer_load_dwordx4 v[156:159], v3, s[44:47], s57 offen offset:3072 nt
    s_addk_i32 s57, 0x4000
    v_mfma_f32_16x16x32_bf16 a[16:19], v[40:43], v[84:87], a[16:19]
    v_mfma_f32_16x16x32_bf16 a[20:23], v[44:47], v[84:87], a[20:23]
    v_mfma_f32_16x16x32_bf16 a[24:27], v[48:51], v[84:87], a[24:27]
    v_mfma_f32_16x16x32_bf16 a[28:31], v[52:55], v[84:87], a[28:31]
    v_perm_b32 v40, v196, v192, s60
    v_perm_b32 v41, v204, v200, s60
    v_perm_b32 v42, v212, v208, s60
    v_perm_b32 v43, v220, v216, s60
    s_waitcnt vmcnt(5)
    buffer_load_dwordx4 v[160:163], v3, s[44:47], s57 offen offset:0 nt
    v_perm_b32 v44, v196, v192, s61
    v_perm_b32 v45, v204, v200, s61
    v_perm_b32 v46, v212, v208, s61
    v_perm_b32 v47, v220, v216, s61
    s_waitcnt vmcnt(5)
    buffer_load_dwordx4 v[164:167], v3, s[44:47], s57 offen offset:1024 nt
    v_perm_b32 v48, v197, v193, s60
    v_perm_b32 v49, v205, v201, s60
    v_perm_b32 v50, v213, v209, s60
    v_perm_b32 v51, v221, v217, s60
    s_waitcnt vmcnt(5)
    buffer_load_dwordx4 v[168:171], v3, s[44:47], s57 offen offset:2048 nt
    v_perm_b32 v52, v197, v193, s61
    v_perm_b32 v53, v205, v201, s61
    v_perm_b32 v54, v213, v209, s61
    v_perm_b32 v55, v221, v217, s61
    s_waitcnt vmcnt(5)
    buffer_load_dwordx4 v[172:175], v3, s[44:47], s57 offen offset:3072 nt
    s_addk_i32 s57, 0x4000
    v_mfma_f32_16x16x32_bf16 a[0:3], v[40:43], v[88:91], a[0:3]
    v_mfma_f32_16x16x32_bf16 a[4:7], v[44:47], v[88:91], a[4:7]
    v_perm_b32 v40, v198, v194, s60
    v_perm_b32 v41, v206, v202, s60
    v_perm_b32 v42, v214, v210, s60
    v_perm_b32 v43, v222, v218, s60
    s_waitcnt vmcnt(5)
    buffer_load_dwordx4 v[176:179], v3, s[44:47], s57 offen offset:0 nt
    v_perm_b32 v44, v198, v194, s61
    v_perm_b32 v45, v206, v202, s61
    v_perm_b32 v46, v214, v210, s61
    v_perm_b32 v47, v222, v218, s61
    s_waitcnt vmcnt(5)
    buffer_load_dwordx4 v[180:183], v3, s[44:47], s57 offen offset:1024 nt
    v_mfma_f32_16x16x32_bf16 a[8:11], v[48:51], v[88:91], a[8:11]
    v_mfma_f32_16x16x32_bf16 a[12:15], v[52:55], v[88:91], a[12:15]
    v_perm_b32 v48, v199, v195, s60
    v_perm_b32 v49, v207, v203, s60
    v_perm_b32 v50, v215, v211, s60
    v_perm_b32 v51, v223, v219, s60
    s_waitcnt vmcnt(5)
    buffer_load_dwordx4 v[184:187], v3, s[44:47], s57 offen offset:2048 nt
    v_perm_b32 v52, v199, v195, s61
    v_perm_b32 v53, v207, v203, s61
    v_perm_b32 v54, v215, v211, s61
    v_perm_b32 v55, v223, v219, s61
    s_waitcnt vmcnt(5)
    buffer_load_dwordx4 v[188:191], v3, s[44:47], s57 offen offset:3072 nt
    s_addk_i32 s57, 0x4000
    v_mfma_f32_16x16x32_bf16 a[16:19], v[40:43], v[88:91], a[16:19]
    v_mfma_f32_16x16x32_bf16 a[20:23], v[44:47], v[88:91], a[20:23]
    v_mfma_f32_16x16x32_bf16 a[24:27], v[48:51], v[88:91], a[24:27]
    v_mfma_f32_16x16x32_bf16 a[28:31], v[52:55], v[88:91], a[28:31]
    v_perm_b32 v40, v228, v224, s60
    v_perm_b32 v41, v236, v232, s60
    v_perm_b32 v42, v244, v240, s60
    v_perm_b32 v43, v252, v248, s60
    s_waitcnt vmcnt(5)
    buffer_load_dwordx4 v[192:195], v3, s[44:47], s57 offen offset:0 nt
    v_perm_b32 v44, v228, v224, s61
    v_perm_b32 v45, v236, v232, s61
    v_perm_b32 v46, v244, v240, s61
    v_perm_b32 v47, v252, v248, s61
    s_waitcnt vmcnt(5)
    buffer_load_dwordx4 v[196:199], v3, s[44:47], s57 offen offset:1024 nt
    v_perm_b32 v48, v229, v225, s60
    v_perm_b32 v49, v237, v233, s60
    v_perm_b32 v50, v245, v241, s60
    v_perm_b32 v51, v253, v249, s60
    s_waitcnt vmcnt(5)
    buffer_load_dwordx4 v[200:203], v3, s[44:47], s57 offen offset:2048 nt
    v_perm_b32 v52, v229, v225, s61
    v_perm_b32 v53, v237, v233, s61
    v_perm_b32 v54, v245, v241, s61
    v_perm_b32 v55, v253, v249, s61
    s_waitcnt vmcnt(5)
    buffer_load_dwordx4 v[204:207], v3, s[44:47], s57 offen offset:3072 nt
    s_addk_i32 s57, 0x4000
    v_mfma_f32_16x16x32_bf16 a[0:3], v[40:43], v[92:95], a[0:3]
    v_mfma_f32_16x16x32_bf16 a[4:7], v[44:47], v[92:95], a[4:7]
    v_perm_b32 v40, v230, v226, s60
    v_perm_b32 v41, v238, v234, s60
    v_perm_b32 v42, v246, v242, s60
    v_perm_b32 v43, v254, v250, s60
    s_waitcnt vmcnt(5)
    buffer_load_dwordx4 v[208:211], v3, s[44:47], s57 offen offset:0 nt
    v_perm_b32 v44, v230, v226, s61
    v_perm_b32 v45, v238, v234, s61
    v_perm_b32 v46, v246, v242, s61
    v_perm_b32 v47, v254, v250, s61
    s_waitcnt vmcnt(5)
    buffer_load_dwordx4 v[212:215], v3, s[44:47], s57 offen offset:1024 nt
    v_mfma_f32_16x16x32_bf16 a[8:11], v[48:51], v[92:95], a[8:11]
    v_mfma_f32_16x16x32_bf16 a[12:15], v[52:55], v[92:95], a[12:15]
    v_perm_b32 v48, v231, v227, s60
    v_perm_b32 v49, v239, v235, s60
    v_perm_b32 v50, v247, v243, s60
    v_perm_b32 v51, v255, v251, s60
    s_waitcnt vmcnt(5)
    buffer_load_dwordx4 v[216:219], v3, s[44:47], s57 offen offset:2048 nt
    v_perm_b32 v52, v231, v227, s61
    v_perm_b32 v53, v239, v235, s61
    v_perm_b32 v54, v247, v243, s61
    v_perm_b32 v55, v255, v251, s61
    s_waitcnt vmcnt(5)
    buffer_load_dwordx4 v[220:223], v3, s[44:47], s57 offen offset:3072 nt
    s_addk_i32 s57, 0x4000
    v_mfma_f32_16x16x32_bf16 a[16:19], v[40:43], v[92:95], a[16:19]
    v_mfma_f32_16x16x32_bf16 a[20:23], v[44:47], v[92:95], a[20:23]
    v_mfma_f32_16x16x32_bf16 a[24:27], v[48:51], v[92:95], a[24:27]
    v_mfma_f32_16x16x32_bf16 a[28:31], v[52:55], v[92:95], a[28:31]
    s_mov_b32 exec_lo, 0x00ff00ff
    s_mov_b32 exec_hi, 0x00ff00ff
    ds_write_b128 v10, a[0:3] offset:11264
    ds_write_b128 v10, a[4:7] offset:11280
    ds_write_b128 v10, a[8:11] offset:11296
    ds_write_b128 v10, a[12:15] offset:11312
    ds_write_b128 v10, a[16:19] offset:11328
    ds_write_b128 v10, a[20:23] offset:11344
    ds_write_b128 v10, a[24:27] offset:11360
    ds_write_b128 v10, a[28:31] offset:11376
    s_mov_b64 exec, -1
    v_perm_b32 v40, v132, v128, s60
    v_perm_b32 v41, v140, v136, s60
    v_perm_b32 v42, v148, v144, s60
    v_perm_b32 v43, v156, v152, s60
    s_waitcnt vmcnt(5)
    buffer_load_dwordx4 v[224:227], v3, s[44:47], s57 offen offset:0 nt
    v_perm_b32 v44, v132, v128, s61
    v_perm_b32 v45, v140, v136, s61
    v_perm_b32 v46, v148, v144, s61
    v_perm_b32 v47, v156, v152, s61
    s_waitcnt vmcnt(5)
    buffer_load_dwordx4 v[228:231], v3, s[44:47], s57 offen offset:1024 nt
    v_perm_b32 v48, v133, v129, s60
    v_perm_b32 v49, v141, v137, s60
    v_perm_b32 v50, v149, v145, s60
    v_perm_b32 v51, v157, v153, s60
    s_waitcnt vmcnt(5)
    buffer_load_dwordx4 v[232:235], v3, s[44:47], s57 offen offset:2048 nt
    v_perm_b32 v52, v133, v129, s61
    v_perm_b32 v53, v141, v137, s61
    v_perm_b32 v54, v149, v145, s61
    v_perm_b32 v55, v157, v153, s61
    s_waitcnt vmcnt(5)
    buffer_load_dwordx4 v[236:239], v3, s[44:47], s57 offen offset:3072 nt
    s_addk_i32 s57, 0x4000
    v_mfma_f32_16x16x32_bf16 a[32:35], v[40:43], v[96:99], 0
    v_mfma_f32_16x16x32_bf16 a[36:39], v[44:47], v[96:99], 0
    v_perm_b32 v40, v134, v130, s60
    v_perm_b32 v41, v142, v138, s60
    v_perm_b32 v42, v150, v146, s60
    v_perm_b32 v43, v158, v154, s60
    s_waitcnt vmcnt(5)
    buffer_load_dwordx4 v[240:243], v3, s[44:47], s57 offen offset:0 nt
    v_perm_b32 v44, v134, v130, s61
    v_perm_b32 v45, v142, v138, s61
    v_perm_b32 v46, v150, v146, s61
    v_perm_b32 v47, v158, v154, s61
    s_waitcnt vmcnt(5)
    buffer_load_dwordx4 v[244:247], v3, s[44:47], s57 offen offset:1024 nt
    v_mfma_f32_16x16x32_bf16 a[40:43], v[48:51], v[96:99], 0
    v_mfma_f32_16x16x32_bf16 a[44:47], v[52:55], v[96:99], 0
    v_perm_b32 v48, v135, v131, s60
    v_perm_b32 v49, v143, v139, s60
    v_perm_b32 v50, v151, v147, s60
    v_perm_b32 v51, v159, v155, s60
    s_waitcnt vmcnt(5)
    buffer_load_dwordx4 v[248:251], v3, s[44:47], s57 offen offset:2048 nt
    v_perm_b32 v52, v135, v131, s61
    v_perm_b32 v53, v143, v139, s61
    v_perm_b32 v54, v151, v147, s61
    v_perm_b32 v55, v159, v155, s61
    s_waitcnt vmcnt(5)
    buffer_load_dwordx4 v[252:255], v3, s[44:47], s57 offen offset:3072 nt
    s_addk_i32 s57, 0x4000
    v_mfma_f32_16x16x32_bf16 a[48:51], v[40:43], v[96:99], 0
    v_mfma_f32_16x16x32_bf16 a[52:55], v[44:47], v[96:99], 0
    v_mfma_f32_16x16x32_bf16 a[56:59], v[48:51], v[96:99], 0
    v_mfma_f32_16x16x32_bf16 a[60:63], v[52:55], v[96:99], 0
    v_perm_b32 v40, v164, v160, s60
    v_perm_b32 v41, v172, v168, s60
    v_perm_b32 v42, v180, v176, s60
    v_perm_b32 v43, v188, v184, s60
    s_waitcnt vmcnt(5)
    buffer_load_dwordx4 v[128:131], v3, s[44:47], s57 offen offset:0 nt
    v_perm_b32 v44, v164, v160, s61
    v_perm_b32 v45, v172, v168, s61
    v_perm_b32 v46, v180, v176, s61
    v_perm_b32 v47, v188, v184, s61
    s_waitcnt vmcnt(5)
    buffer_load_dwordx4 v[132:135], v3, s[44:47], s57 offen offset:1024 nt
    v_perm_b32 v48, v165, v161, s60
    v_perm_b32 v49, v173, v169, s60
    v_perm_b32 v50, v181, v177, s60
    v_perm_b32 v51, v189, v185, s60
    s_waitcnt vmcnt(5)
    buffer_load_dwordx4 v[136:139], v3, s[44:47], s57 offen offset:2048 nt
    v_perm_b32 v52, v165, v161, s61
    v_perm_b32 v53, v173, v169, s61
    v_perm_b32 v54, v181, v177, s61
    v_perm_b32 v55, v189, v185, s61
    s_waitcnt vmcnt(5)
    buffer_load_dwordx4 v[140:143], v3, s[44:47], s57 offen offset:3072 nt
    s_addk_i32 s57, 0x4000
    v_mfma_f32_16x16x32_bf16 a[32:35], v[40:43], v[100:103], a[32:35]
    v_mfma_f32_16x16x32_bf16 a[36:39], v[44:47], v[100:103], a[36:39]
    v_perm_b32 v40, v166, v162, s60
    v_perm_b32 v41, v174, v170, s60
    v_perm_b32 v42, v182, v178, s60
    v_perm_b32 v43, v190, v186, s60
    s_waitcnt vmcnt(5)
    buffer_load_dwordx4 v[144:147], v3, s[44:47], s57 offen offset:0 nt
    v_perm_b32 v44, v166, v162, s61
    v_perm_b32 v45, v174, v170, s61
    v_perm_b32 v46, v182, v178, s61
    v_perm_b32 v47, v190, v186, s61
    s_waitcnt vmcnt(5)
    buffer_load_dwordx4 v[148:151], v3, s[44:47], s57 offen offset:1024 nt
    v_mfma_f32_16x16x32_bf16 a[40:43], v[48:51], v[100:103], a[40:43]
    v_mfma_f32_16x16x32_bf16 a[44:47], v[52:55], v[100:103], a[44:47]
    v_perm_b32 v48, v167, v163, s60
    v_perm_b32 v49, v175, v171, s60
    v_perm_b32 v50, v183, v179, s60
    v_perm_b32 v51, v191, v187, s60
    s_waitcnt vmcnt(5)
    buffer_load_dwordx4 v[152:155], v3, s[44:47], s57 offen offset:2048 nt
    v_perm_b32 v52, v167, v163, s61
    v_perm_b32 v53, v175, v171, s61
    v_perm_b32 v54, v183, v179, s61
    v_perm_b32 v55, v191, v187, s61
    s_waitcnt vmcnt(5)
    buffer_load_dwordx4 v[156:159], v3, s[44:47], s57 offen offset:3072 nt
    s_addk_i32 s57, 0x4000
    v_mfma_f32_16x16x32_bf16 a[48:51], v[40:43], v[100:103], a[48:51]
    v_mfma_f32_16x16x32_bf16 a[52:55], v[44:47], v[100:103], a[52:55]
    v_mfma_f32_16x16x32_bf16 a[56:59], v[48:51], v[100:103], a[56:59]
    v_mfma_f32_16x16x32_bf16 a[60:63], v[52:55], v[100:103], a[60:63]
    global_load_dword v18, v19, s[22:23] sc1
    buffer_load_dwordx2 v[56:57], v9, s[48:51], s77 offen sc1
    v_perm_b32 v40, v196, v192, s60
    v_perm_b32 v41, v204, v200, s60
    v_perm_b32 v42, v212, v208, s60
    v_perm_b32 v43, v220, v216, s60
    s_waitcnt vmcnt(7)
    buffer_load_dwordx4 v[160:163], v3, s[44:47], s57 offen offset:0 nt
    v_perm_b32 v44, v196, v192, s61
    v_perm_b32 v45, v204, v200, s61
    v_perm_b32 v46, v212, v208, s61
    v_perm_b32 v47, v220, v216, s61
    s_waitcnt vmcnt(7)
    buffer_load_dwordx4 v[164:167], v3, s[44:47], s57 offen offset:1024 nt
    v_perm_b32 v48, v197, v193, s60
    v_perm_b32 v49, v205, v201, s60
    v_perm_b32 v50, v213, v209, s60
    v_perm_b32 v51, v221, v217, s60
    s_waitcnt vmcnt(7)
    buffer_load_dwordx4 v[168:171], v3, s[44:47], s57 offen offset:2048 nt
    v_perm_b32 v52, v197, v193, s61
    v_perm_b32 v53, v205, v201, s61
    v_perm_b32 v54, v213, v209, s61
    v_perm_b32 v55, v221, v217, s61
    s_waitcnt vmcnt(7)
    buffer_load_dwordx4 v[172:175], v3, s[44:47], s57 offen offset:3072 nt
    s_addk_i32 s57, 0x4000
    v_mfma_f32_16x16x32_bf16 a[32:35], v[40:43], v[104:107], a[32:35]
    v_mfma_f32_16x16x32_bf16 a[36:39], v[44:47], v[104:107], a[36:39]
    v_perm_b32 v40, v198, v194, s60
    v_perm_b32 v41, v206, v202, s60
    v_perm_b32 v42, v214, v210, s60
    v_perm_b32 v43, v222, v218, s60
    s_waitcnt vmcnt(7)
    buffer_load_dwordx4 v[176:179], v3, s[44:47], s57 offen offset:0 nt
    v_perm_b32 v44, v198, v194, s61
    v_perm_b32 v45, v206, v202, s61
    v_perm_b32 v46, v214, v210, s61
    v_perm_b32 v47, v222, v218, s61
    s_waitcnt vmcnt(7)
    buffer_load_dwordx4 v[180:183], v3, s[44:47], s57 offen offset:1024 nt
    v_mfma_f32_16x16x32_bf16 a[40:43], v[48:51], v[104:107], a[40:43]
    v_mfma_f32_16x16x32_bf16 a[44:47], v[52:55], v[104:107], a[44:47]
    v_perm_b32 v48, v199, v195, s60
    v_perm_b32 v49, v207, v203, s60
    v_perm_b32 v50, v215, v211, s60
    v_perm_b32 v51, v223, v219, s60
    s_waitcnt vmcnt(5)
    buffer_load_dwordx4 v[184:187], v3, s[44:47], s57 offen offset:2048 nt
    v_perm_b32 v52, v199, v195, s61
    v_perm_b32 v53, v207, v203, s61
    v_perm_b32 v54, v215, v211, s61
    v_perm_b32 v55, v223, v219, s61
    s_waitcnt vmcnt(5)
    buffer_load_dwordx4 v[188:191], v3, s[44:47], s57 offen offset:3072 nt
    s_addk_i32 s57, 0x4000
    v_mfma_f32_16x16x32_bf16 a[48:51], v[40:43], v[104:107], a[48:51]
    v_mfma_f32_16x16x32_bf16 a[52:55], v[44:47], v[104:107], a[52:55]
    v_mfma_f32_16x16x32_bf16 a[56:59], v[48:51], v[104:107], a[56:59]
    v_mfma_f32_16x16x32_bf16 a[60:63], v[52:55], v[104:107], a[60:63]
    s_getpc_b64 s[28:29]
L_pf:
    s_add_u32 s28, s28, L_tail - L_pf
    s_addc_u32 s29, s29, 0
    s_mov_b32 s30, L_codeend - L_tail
    s_mov_b32 s31, 0x20000
    buffer_load_dwordx4 v[28:31], v13, s[28:31], 0 offen
    v_perm_b32 v40, v228, v224, s60
    v_perm_b32 v41, v236, v232, s60
    v_perm_b32 v42, v244, v240, s60
    v_perm_b32 v43, v252, v248, s60
    s_waitcnt vmcnt(6)
    buffer_load_dwordx4 v[192:195], v3, s[44:47], s57 offen offset:0 nt
    v_perm_b32 v44, v228, v224, s61
    v_perm_b32 v45, v236, v232, s61
    v_perm_b32 v46, v244, v240, s61
    v_perm_b32 v47, v252, v248, s61
    s_waitcnt vmcnt(6)
    buffer_load_dwordx4 v[196:199], v3, s[44:47], s57 offen offset:1024 nt
    v_perm_b32 v48, v229, v225, s60
    v_perm_b32 v49, v237, v233, s60
    v_perm_b32 v50, v245, v241, s60
    v_perm_b32 v51, v253, v249, s60
    s_waitcnt vmcnt(6)
    buffer_load_dwordx4 v[200:203], v3, s[44:47], s57 offen offset:2048 nt
    v_perm_b32 v52, v229, v225, s61
    v_perm_b32 v53, v237, v233, s61
    v_perm_b32 v54, v245, v241, s61
    v_perm_b32 v55, v253, v249, s61
    s_waitcnt vmcnt(6)
    buffer_load_dwordx4 v[204:207], v3, s[44:47], s57 offen offset:3072 nt
    s_addk_i32 s57, 0x4000
    v_mfma_f32_16x16x32_bf16 a[32:35], v[40:43], v[108:111], a[32:35]
    v_mfma_f32_16x16x32_bf16 a[36:39], v[44:47], v[108:111], a[36:39]
    v_perm_b32 v40, v230, v226, s60
    v_perm_b32 v41, v238, v234, s60
    v_perm_b32 v42, v246, v242, s60
    v_perm_b32 v43, v254, v250, s60
    s_waitcnt vmcnt(6)
    buffer_load_dwordx4 v[208:211], v3, s[44:47], s57 offen offset:0 nt
    v_perm_b32 v44, v230, v226, s61
    v_perm_b32 v45, v238, v234, s61
    v_perm_b32 v46, v246, v242, s61
    v_perm_b32 v47, v254, v250, s61
    s_waitcnt vmcnt(6)
    buffer_load_dwordx4 v[212:215], v3, s[44:47], s57 offen offset:1024 nt
    v_mfma_f32_16x16x32_bf16 a[40:43], v[48:51], v[108:111], a[40:43]
    v_mfma_f32_16x16x32_bf16 a[44:47], v[52:55], v[108:111], a[44:47]
    v_perm_b32 v48, v231, v227, s60
    v_perm_b32 v49, v239, v235, s60
    v_perm_b32 v50, v247, v243, s60
    v_perm_b32 v51, v255, v251, s60
    s_waitcnt vmcnt(5)
    buffer_load_dwordx4 v[216:219], v3, s[44:47], s57 offen offset:2048 nt
    v_perm_b32 v52, v231, v227, s61
    v_perm_b32 v53, v239, v235, s61
    v_perm_b32 v54, v247, v243, s61
    v_perm_b32 v55, v255, v251, s61
    s_waitcnt vmcnt(5)
    buffer_load_dwordx4 v[220:223], v3, s[44:47], s57 offen offset:3072 nt
    s_addk_i32 s57, 0x4000
    v_mfma_f32_16x16x32_bf16 a[48:51], v[40:43], v[108:111], a[48:51]
    v_mfma_f32_16x16x32_bf16 a[52:55], v[44:47], v[108:111], a[52:55]
    v_mfma_f32_16x16x32_bf16 a[56:59], v[48:51], v[108:111], a[56:59]
    v_mfma_f32_16x16x32_bf16 a[60:63], v[52:55], v[108:111], a[60:63]
    v_max_u32 v12, v56, v57
    v_cmp_gt_u32 s[64:65], 32, v18
    v_cmp_eq_u32 s[4:5], -1, v12
    s_or_b64 s[4:5], s[4:5], s[64:65]
    s_cbranch_scc1 L_mlslow
L_mlok:
    v_mov_b32 v12, v56
    s_nop 1
    v_max_f32_dpp v12, v12, v12 row_ror:1 row_mask:0xf bank_mask:0xf
    s_nop 1
    v_max_f32_dpp v12, v12, v12 row_ror:2 row_mask:0xf bank_mask:0xf
    s_nop 1
    v_max_f32_dpp v12, v12, v12 row_ror:4 row_mask:0xf bank_mask:0xf
    s_nop 1
    v_max_f32_dpp v12, v12, v12 row_ror:8 row_mask:0xf bank_mask:0xf
    v_mov_b32 v59, v12
    s_nop 1
    v_permlane16_swap_b32 v12, v59
    v_max_f32 v12, v12, v59
    v_sub_f32 v58, v56, v12
    v_exp_f32 v58, v58
    s_nop 0
    v_mul_f32 v12, v58, v57
    s_nop 1
    v_add_f32_dpp v12, v12, v12 row_ror:1 row_mask:0xf bank_mask:0xf
    s_nop 1
    v_add_f32_dpp v12, v12, v12 row_ror:2 row_mask:0xf bank_mask:0xf
    s_nop 1
    v_add_f32_dpp v12, v12, v12 row_ror:4 row_mask:0xf bank_mask:0xf
    s_nop 1
    v_add_f32_dpp v12, v12, v12 row_ror:8 row_mask:0xf bank_mask:0xf
    v_mov_b32 v59, v12
    s_nop 1
    v_permlane16_swap_b32 v12, v59
    v_add_f32 v12, v12, v59
    v_rcp_f32 v12, v12
    s_nop 0
    v_mul_f32 v58, v58, v12
    ds_bpermute_b32 v20, v14, v58 offset:0
    ds_bpermute_b32 v21, v14, v58 offset:32
    ds_bpermute_b32 v22, v14, v58 offset:64
    ds_bpermute_b32 v23, v14, v58 offset:96
    s_waitcnt lgkmcnt(0)
    v_perm_b32 v40, v132, v128, s60
    v_perm_b32 v41, v140, v136, s60
    v_perm_b32 v42, v148, v144, s60
    v_perm_b32 v43, v156, v152, s60
    s_waitcnt vmcnt(5)
    buffer_load_dwordx4 v[224:227], v3, s[44:47], s57 offen offset:0 nt
    v_perm_b32 v44, v132, v128, s61
    v_perm_b32 v45, v140, v136, s61
    v_perm_b32 v46, v148, v144, s61
    v_perm_b32 v47, v156, v152, s61
    s_waitcnt vmcnt(5)
    buffer_load_dwordx4 v[228:231], v3, s[44:47], s57 offen offset:1024 nt
    v_perm_b32 v48, v133, v129, s60
    v_perm_b32 v49, v141, v137, s60
    v_perm_b32 v50, v149, v145, s60
    v_perm_b32 v51, v157, v153, s60
    s_waitcnt vmcnt(5)
    buffer_load_dwordx4 v[232:235], v3, s[44:47], s57 offen offset:2048 nt
    v_perm_b32 v52, v133, v129, s61
    v_perm_b32 v53, v141, v137, s61
    v_perm_b32 v54, v149, v145, s61
    v_perm_b32 v55, v157, v153, s61
    s_waitcnt vmcnt(5)
    buffer_load_dwordx4 v[236:239], v3, s[44:47], s57 offen offset:3072 nt
    s_addk_i32 s57, 0x4000
    v_mfma_f32_16x16x32_bf16 a[32:35], v[40:43], v[112:115], a[32:35]
    v_mfma_f32_16x16x32_bf16 a[36:39], v[44:47], v[112:115], a[36:39]
    v_perm_b32 v40, v134, v130, s60
    v_perm_b32 v41, v142, v138, s60
    v_perm_b32 v42, v150, v146, s60
    v_perm_b32 v43, v158, v154, s60
    s_waitcnt vmcnt(5)
    buffer_load_dwordx4 v[240:243], v3, s[44:47], s57 offen offset:0 nt
    v_perm_b32 v44, v134, v130, s61
    v_perm_b32 v45, v142, v138, s61
    v_perm_b32 v46, v150, v146, s61
    v_perm_b32 v47, v158, v154, s61
    s_waitcnt vmcnt(5)
    buffer_load_dwordx4 v[244:247], v3, s[44:47], s57 offen offset:1024 nt
    v_mfma_f32_16x16x32_bf16 a[40:43], v[48:51], v[112:115], a[40:43]
    v_mfma_f32_16x16x32_bf16 a[44:47], v[52:55], v[112:115], a[44:47]
    v_perm_b32 v48, v135, v131, s60
    v_perm_b32 v49, v143, v139, s60
    v_perm_b32 v50, v151, v147, s60
    v_perm_b32 v51, v159, v155, s60
    s_waitcnt vmcnt(5)
    buffer_load_dwordx4 v[248:251], v3, s[44:47], s57 offen offset:2048 nt
    v_perm_b32 v52, v135, v131, s61
    v_perm_b32 v53, v143, v139, s61
    v_perm_b32 v54, v151, v147, s61
    v_perm_b32 v55, v159, v155, s61
    s_waitcnt vmcnt(5)
    buffer_load_dwordx4 v[252:255], v3, s[44:47], s57 offen offset:3072 nt
    s_lshl_b32 s57, s26, 12
    v_mfma_f32_16x16x32_bf16 a[48:51], v[40:43], v[112:115], a[48:51]
    v_mfma_f32_16x16x32_bf16 a[52:55], v[44:47], v[112:115], a[52:55]
    v_mfma_f32_16x16x32_bf16 a[56:59], v[48:51], v[112:115], a[56:59]
    v_mfma_f32_16x16x32_bf16 a[60:63], v[52:55], v[112:115], a[60:63]
    s_waitcnt lgkmcnt(0)
    s_barrier
    ds_read_b128 v[24:27], v11 offset:11264
    ds_read_b128 v[28:31], v11 offset:15488
    ds_read_b128 v[32:35], v11 offset:19712
    ds_read_b128 v[36:39], v11 offset:23936
    s_waitcnt lgkmcnt(0)
    v_pk_add_f32 v[24:25], v[24:25], v[28:29]
    v_pk_add_f32 v[26:27], v[26:27], v[30:31]
    v_pk_add_f32 v[32:33], v[32:33], v[36:37]
    v_pk_add_f32 v[34:35], v[34:35], v[38:39]
    v_pk_add_f32 v[24:25], v[24:25], v[32:33]
    v_pk_add_f32 v[26:27], v[26:27], v[34:35]
    buffer_store_dwordx4 v[24:27], v13, s[48:51], s73 offen sc1
    v_perm_b32 v40, v164, v160, s60
    v_perm_b32 v41, v172, v168, s60
    v_perm_b32 v42, v180, v176, s60
    v_perm_b32 v43, v188, v184, s60
    v_perm_b32 v44, v164, v160, s61
    v_perm_b32 v45, v172, v168, s61
    v_perm_b32 v46, v180, v176, s61
    v_perm_b32 v47, v188, v184, s61
    v_perm_b32 v48, v165, v161, s60
    v_perm_b32 v49, v173, v169, s60
    v_perm_b32 v50, v181, v177, s60
    v_perm_b32 v51, v189, v185, s60
    v_perm_b32 v52, v165, v161, s61
    v_perm_b32 v53, v173, v169, s61
    v_perm_b32 v54, v181, v177, s61
    v_perm_b32 v55, v189, v185, s61
    v_mfma_f32_16x16x32_bf16 a[32:35], v[40:43], v[116:119], a[32:35]
    v_mfma_f32_16x16x32_bf16 a[36:39], v[44:47], v[116:119], a[36:39]
    v_perm_b32 v40, v166, v162, s60
    v_perm_b32 v41, v174, v170, s60
    v_perm_b32 v42, v182, v178, s60
    v_perm_b32 v43, v190, v186, s60
    v_perm_b32 v44, v166, v162, s61
    v_perm_b32 v45, v174, v170, s61
    v_perm_b32 v46, v182, v178, s61
    v_perm_b32 v47, v190, v186, s61
    v_mfma_f32_16x16x32_bf16 a[40:43], v[48:51], v[116:119], a[40:43]
    v_mfma_f32_16x16x32_bf16 a[44:47], v[52:55], v[116:119], a[44:47]
    v_perm_b32 v48, v167, v163, s60
    v_perm_b32 v49, v175, v171, s60
    v_perm_b32 v50, v183, v179, s60
    v_perm_b32 v51, v191, v187, s60
    v_perm_b32 v52, v167, v163, s61
    v_perm_b32 v53, v175, v171, s61
    v_perm_b32 v54, v183, v179, s61
    v_perm_b32 v55, v191, v187, s61
    v_mfma_f32_16x16x32_bf16 a[48:51], v[40:43], v[116:119], a[48:51]
    v_mfma_f32_16x16x32_bf16 a[52:55], v[44:47], v[116:119], a[52:55]
    v_mfma_f32_16x16x32_bf16 a[56:59], v[48:51], v[116:119], a[56:59]
    v_mfma_f32_16x16x32_bf16 a[60:63], v[52:55], v[116:119], a[60:63]
    v_perm_b32 v40, v196, v192, s60
    v_perm_b32 v41, v204, v200, s60
    v_perm_b32 v42, v212, v208, s60
    v_perm_b32 v43, v220, v216, s60
    buffer_load_dwordx4 v[128:131], v4, s[40:43], 0 offen offset:0 nt
    v_perm_b32 v44, v196, v192, s61
    v_perm_b32 v45, v204, v200, s61
    v_perm_b32 v46, v212, v208, s61
    v_perm_b32 v47, v220, v216, s61
    buffer_load_dwordx4 v[132:135], v4, s[40:43], s68 offen offset:0 nt
    v_perm_b32 v48, v197, v193, s60
    v_perm_b32 v49, v205, v201, s60
    v_perm_b32 v50, v213, v209, s60
    v_perm_b32 v51, v221, v217, s60
    buffer_load_dwordx4 v[136:139], v4, s[40:43], s69 offen offset:0 nt
    v_perm_b32 v52, v197, v193, s61
    v_perm_b32 v53, v205, v201, s61
    v_perm_b32 v54, v213, v209, s61
    v_perm_b32 v55, v221, v217, s61
    buffer_load_dwordx4 v[140:143], v4, s[40:43], s70 offen offset:0 nt
    v_mfma_f32_16x16x32_bf16 a[32:35], v[40:43], v[120:123], a[32:35]
    v_mfma_f32_16x16x32_bf16 a[36:39], v[44:47], v[120:123], a[36:39]
    v_perm_b32 v40, v198, v194, s60
    v_perm_b32 v41, v206, v202, s60
    v_perm_b32 v42, v214, v210, s60
    v_perm_b32 v43, v222, v218, s60
    buffer_load_dwordx4 v[144:147], v4, s[40:43], 0 offen offset:2048 nt
    v_perm_b32 v44, v198, v194, s61
    v_perm_b32 v45, v206, v202, s61
    v_perm_b32 v46, v214, v210, s61
    v_perm_b32 v47, v222, v218, s61
    buffer_load_dwordx4 v[148:151], v4, s[40:43], s68 offen offset:2048 nt
    v_mfma_f32_16x16x32_bf16 a[40:43], v[48:51], v[120:123], a[40:43]
    v_mfma_f32_16x16x32_bf16 a[44:47], v[52:55], v[120:123], a[44:47]
    v_perm_b32 v48, v199, v195, s60
    v_perm_b32 v49, v207, v203, s60
    v_perm_b32 v50, v215, v211, s60
    v_perm_b32 v51, v223, v219, s60
    buffer_load_dwordx4 v[152:155], v4, s[40:43], s69 offen offset:2048 nt
    v_perm_b32 v52, v199, v195, s61
    v_perm_b32 v53, v207, v203, s61
    v_perm_b32 v54, v215, v211, s61
    v_perm_b32 v55, v223, v219, s61
    buffer_load_dwordx4 v[156:159], v4, s[40:43], s70 offen offset:2048 nt
    v_mfma_f32_16x16x32_bf16 a[48:51], v[40:43], v[120:123], a[48:51]
    v_mfma_f32_16x16x32_bf16 a[52:55], v[44:47], v[120:123], a[52:55]
    v_mfma_f32_16x16x32_bf16 a[56:59], v[48:51], v[120:123], a[56:59]
    v_mfma_f32_16x16x32_bf16 a[60:63], v[52:55], v[120:123], a[60:63]
    s_waitcnt vmcnt(9)
    v_perm_b32 v40, v228, v224, s60
    v_perm_b32 v41, v236, v232, s60
    v_perm_b32 v42, v244, v240, s60
    v_perm_b32 v43, v252, v248, s60
    v_perm_b32 v44, v228, v224, s61
    v_perm_b32 v45, v236, v232, s61
    v_perm_b32 v46, v244, v240, s61
    v_perm_b32 v47, v252, v248, s61
    v_perm_b32 v48, v229, v225, s60
    v_perm_b32 v49, v237, v233, s60
    v_perm_b32 v50, v245, v241, s60
    v_perm_b32 v51, v253, v249, s60
    v_perm_b32 v52, v229, v225, s61
    v_perm_b32 v53, v237, v233, s61
    v_perm_b32 v54, v245, v241, s61
    v_perm_b32 v55, v253, v249, s61
    v_mfma_f32_16x16x32_bf16 a[32:35], v[40:43], v[124:127], a[32:35]
    v_mfma_f32_16x16x32_bf16 a[36:39], v[44:47], v[124:127], a[36:39]
    v_perm_b32 v40, v230, v226, s60
    v_perm_b32 v41, v238, v234, s60
    v_perm_b32 v42, v246, v242, s60
    v_perm_b32 v43, v254, v250, s60
    v_perm_b32 v44, v230, v226, s61
    v_perm_b32 v45, v238, v234, s61
    v_perm_b32 v46, v246, v242, s61
    v_perm_b32 v47, v254, v250, s61
    v_mfma_f32_16x16x32_bf16 a[40:43], v[48:51], v[124:127], a[40:43]
    v_mfma_f32_16x16x32_bf16 a[44:47], v[52:55], v[124:127], a[44:47]
    v_perm_b32 v48, v231, v227, s60
    v_perm_b32 v49, v239, v235, s60
    v_perm_b32 v50, v247, v243, s60
    v_perm_b32 v51, v255, v251, s60
    v_perm_b32 v52, v231, v227, s61
    v_perm_b32 v53, v239, v235, s61
    v_perm_b32 v54, v247, v243, s61
    v_perm_b32 v55, v255, v251, s61
    v_mfma_f32_16x16x32_bf16 a[48:51], v[40:43], v[124:127], a[48:51]
    v_mfma_f32_16x16x32_bf16 a[52:55], v[44:47], v[124:127], a[52:55]
    v_mfma_f32_16x16x32_bf16 a[56:59], v[48:51], v[124:127], a[56:59]
    v_mfma_f32_16x16x32_bf16 a[60:63], v[52:55], v[124:127], a[60:63]
L_tail:
    s_mov_b32 exec_lo, 0x00ff00ff
    s_mov_b32 exec_hi, 0x00ff00ff
    ds_write_b128 v10, a[32:35] offset:28160
    ds_write_b128 v10, a[36:39] offset:28176
    ds_write_b128 v10, a[40:43] offset:28192
    ds_write_b128 v10, a[44:47] offset:28208
    ds_write_b128 v10, a[48:51] offset:28224
    ds_write_b128 v10, a[52:55] offset:28240
    ds_write_b128 v10, a[56:59] offset:28256
    ds_write_b128 v10, a[60:63] offset:28272
    s_mov_b64 exec, -1
    s_waitcnt lgkmcnt(0)
    s_barrier
    ds_read_b128 v[24:27], v11 offset:28160
    ds_read_b128 v[28:31], v11 offset:32384
    ds_read_b128 v[32:35], v11 offset:36608
    ds_read_b128 v[36:39], v11 offset:40832
    s_waitcnt lgkmcnt(0)
    v_pk_add_f32 v[24:25], v[24:25], v[28:29]
    v_pk_add_f32 v[26:27], v[26:27], v[30:31]
    v_pk_add_f32 v[32:33], v[32:33], v[36:37]
    v_pk_add_f32 v[34:35], v[34:35], v[38:39]
    v_pk_add_f32 v[24:25], v[24:25], v[32:33]
    v_pk_add_f32 v[26:27], v[26:27], v[34:35]
    buffer_store_dwordx4 v[24:27], v13, s[48:51], s75 offen sc1
    buffer_load_dwordx4 v[160:163], v2, s[40:43], 0 offen offset:0 nt
    buffer_load_dwordx4 v[164:167], v2, s[40:43], s68 offen offset:0 nt
    buffer_load_dwordx4 v[168:171], v2, s[40:43], s69 offen offset:0 nt
    buffer_load_dwordx4 v[172:175], v2, s[40:43], s70 offen offset:0 nt
    buffer_load_dwordx4 v[176:179], v2, s[40:43], 0 offen offset:2048 nt
    buffer_load_dwordx4 v[180:183], v2, s[40:43], s68 offen offset:2048 nt
    buffer_load_dwordx4 v[184:187], v2, s[40:43], s69 offen offset:2048 nt
    buffer_load_dwordx4 v[188:191], v2, s[40:43], s70 offen offset:2048 nt
    s_waitcnt vmcnt(9)
    v_perm_b32 v64, v132, v128, s60
    v_perm_b32 v65, v140, v136, s60
    v_perm_b32 v66, v148, v144, s60
    v_perm_b32 v67, v156, v152, s60
    v_perm_b32 v68, v132, v128, s61
    v_perm_b32 v69, v140, v136, s61
    v_perm_b32 v70, v148, v144, s61
    v_perm_b32 v71, v156, v152, s61
    v_perm_b32 v72, v133, v129, s60
    v_perm_b32 v73, v141, v137, s60
    v_perm_b32 v74, v149, v145, s60
    v_perm_b32 v75, v157, v153, s60
    v_perm_b32 v76, v133, v129, s61
    v_perm_b32 v77, v141, v137, s61
    v_perm_b32 v78, v149, v145, s61
    v_perm_b32 v79, v157, v153, s61
    v_perm_b32 v80, v134, v130, s60
    v_perm_b32 v81, v142, v138, s60
    v_perm_b32 v82, v150, v146, s60
    v_perm_b32 v83, v158, v154, s60
    v_perm_b32 v84, v134, v130, s61
    v_perm_b32 v85, v142, v138, s61
    v_perm_b32 v86, v150, v146, s61
    v_perm_b32 v87, v158, v154, s61
    v_perm_b32 v88, v135, v131, s60
    v_perm_b32 v89, v143, v139, s60
    v_perm_b32 v90, v151, v147, s60
    v_perm_b32 v91, v159, v155, s60
    v_perm_b32 v92, v135, v131, s61
    v_perm_b32 v93, v143, v139, s61
    v_perm_b32 v94, v151, v147, s61
    v_perm_b32 v95, v159, v155, s61
    s_mov_b32 s63, 2048
    s_mov_b32 s7, 32
    buffer_load_dwordx4 v[32:35], v8, s[48:51], s8 offen sc1
    buffer_load_dwordx4 v[36:39], v8, s[48:51], s9 offen sc1
    buffer_load_dwordx4 v[40:43], v8, s[48:51], s10 offen sc1
    buffer_load_dwordx4 v[44:47], v8, s[48:51], s11 offen sc1
    s_waitcnt vmcnt(4)
    v_perm_b32 v96, v164, v160, s60
    v_perm_b32 v97, v172, v168, s60
    v_perm_b32 v98, v180, v176, s60
    v_perm_b32 v99, v188, v184, s60
    v_perm_b32 v100, v164, v160, s61
    v_perm_b32 v101, v172, v168, s61
    v_perm_b32 v102, v180, v176, s61
    v_perm_b32 v103, v188, v184, s61
    v_perm_b32 v104, v165, v161, s60
    v_perm_b32 v105, v173, v169, s60
    v_perm_b32 v106, v181, v177, s60
    v_perm_b32 v107, v189, v185, s60
    v_perm_b32 v108, v165, v161, s61
    v_perm_b32 v109, v173, v169, s61
    v_perm_b32 v110, v181, v177, s61
    v_perm_b32 v111, v189, v185, s61
    v_perm_b32 v112, v166, v162, s60
    v_perm_b32 v113, v174, v170, s60
    v_perm_b32 v114, v182, v178, s60
    v_perm_b32 v115, v190, v186, s60
    v_perm_b32 v116, v166, v162, s61
    v_perm_b32 v117, v174, v170, s61
    v_perm_b32 v118, v182, v178, s61
    v_perm_b32 v119, v190, v186, s61
    v_perm_b32 v120, v167, v163, s60
    v_perm_b32 v121, v175, v171, s60
    v_perm_b32 v122, v183, v179, s60
    v_perm_b32 v123, v191, v187, s60
    v_perm_b32 v124, v167, v163, s61
    v_perm_b32 v125, v175, v171, s61
    v_perm_b32 v126, v183, v179, s61
    v_perm_b32 v127, v191, v187, s61
L_h1:
    s_waitcnt vmcnt(0)
    v_mul_f32 v56, v20, v32
    v_mul_f32 v57, v20, v33
    v_mul_f32 v58, v20, v34
    v_mul_f32 v59, v20, v35
    v_fmac_f32 v56, v21, v36
    v_fmac_f32 v57, v21, v37
    v_fmac_f32 v58, v21, v38
    v_fmac_f32 v59, v21, v39
    v_fmac_f32 v56, v22, v40
    v_fmac_f32 v57, v22, v41
    v_fmac_f32 v58, v22, v42
    v_fmac_f32 v59, v22, v43
    v_fmac_f32 v56, v23, v44
    v_fmac_f32 v57, v23, v45
    v_fmac_f32 v58, v23, v46
    v_fmac_f32 v59, v23, v47
    v_cmp_u_f32 vcc, v56, v57
    v_cmp_u_f32 s[4:5], v58, v59
    s_or_b64 exec, vcc, s[4:5]
    s_cbranch_scc1 L_h1r
L_h1ok:
    s_mov_b64 exec, -1
    v_permlane32_swap_b32 v56, v57
    v_permlane32_swap_b32 v58, v59
    v_add_f32 v56, v56, v57
    v_add_f32 v58, v58, v59
    s_nop 1
    v_permlane16_swap_b32 v56, v58
    v_add_f32 v56, v56, v58
    s_nop 1
    v_add_f32_dpp v56, v56, v56 row_ror:8 row_mask:0xf bank_mask:0xf
    v_cvt_pk_bf16_f32 v56, v56, v56
    ds_write_b16 v16, v56
    s_waitcnt lgkmcnt(0)
    s_barrier
    ds_read_b128 v[24:27], v15
    ds_read_b128 v[28:31], v15 offset:128
    s_waitcnt lgkmcnt(0)
    v_mfma_f32_16x16x32_bf16 v[192:195], v[64:67], v[24:27], 0
    v_mfma_f32_16x16x32_bf16 v[192:195], v[96:99], v[28:31], v[192:195]
    v_mfma_f32_16x16x32_bf16 v[196:199], v[68:71], v[24:27], 0
    v_mfma_f32_16x16x32_bf16 v[196:199], v[100:103], v[28:31], v[196:199]
    v_mfma_f32_16x16x32_bf16 v[200:203], v[72:75], v[24:27], 0
    v_mfma_f32_16x16x32_bf16 v[200:203], v[104:107], v[28:31], v[200:203]
    v_mfma_f32_16x16x32_bf16 v[204:207], v[76:79], v[24:27], 0
    v_mfma_f32_16x16x32_bf16 v[204:207], v[108:111], v[28:31], v[204:207]
    v_mfma_f32_16x16x32_bf16 v[208:211], v[80:83], v[24:27], 0
    v_mfma_f32_16x16x32_bf16 v[208:211], v[112:115], v[28:31], v[208:211]
    buffer_store_dwordx4 v[192:195], v5, s[48:51], s74 offen offset:0 sc1
    v_mfma_f32_16x16x32_bf16 v[212:215], v[84:87], v[24:27], 0
    v_mfma_f32_16x16x32_bf16 v[212:215], v[116:119], v[28:31], v[212:215]
    buffer_store_dwordx4 v[196:199], v5, s[48:51], s74 offen offset:128 sc1
    v_mfma_f32_16x16x32_bf16 v[216:219], v[88:91], v[24:27], 0
    v_mfma_f32_16x16x32_bf16 v[216:219], v[120:123], v[28:31], v[216:219]
    buffer_store_dwordx4 v[200:203], v5, s[48:51], s74 offen offset:256 sc1
    v_mfma_f32_16x16x32_bf16 v[220:223], v[92:95], v[24:27], 0
    v_mfma_f32_16x16x32_bf16 v[220:223], v[124:127], v[28:31], v[220:223]
    buffer_store_dwordx4 v[204:207], v5, s[48:51], s74 offen offset:384 sc1
    buffer_store_dwordx4 v[208:211], v5, s[48:51], s74 offen offset:512 sc1
    buffer_store_dwordx4 v[212:215], v5, s[48:51], s74 offen offset:640 sc1
    s_nop 1
    buffer_store_dwordx4 v[216:219], v5, s[48:51], s74 offen offset:768 sc1
    s_nop 1
    buffer_store_dwordx4 v[220:223], v5, s[48:51], s74 offen offset:896 sc1
    s_cmp_lg_u32 s26, 0
    s_cbranch_scc1 L_end
    v_lshrrev_b32 v8, 2, v1
    v_lshlrev_b32 v8, 12, v8
    v_and_b32 v9, 3, v1
    v_lshl_or_b32 v8, v9, 4, v8
    s_lshr_b32 s4, s2, 6
    s_lshl_b32 s4, s4, 18
    s_and_b32 s5, s2, 63
    s_lshl_b32 s6, s5, 6
    s_add_u32 s4, s4, s6
    s_add_u32 s28, s4, 4194304
    s_add_u32 s29, s28, 0x10000
    s_add_u32 s30, s29, 0x10000
    s_add_u32 s31, s30, 0x10000
    s_lshr_b32 s6, s2, 4
    s_lshl_b32 s6, s6, 7
    s_and_b32 s7, s5, 1
    s_lshl_b32 s7, s7, 6
    s_add_u32 s6, s6, s7
    s_bfe_u32 s7, s5, 0x30001
    s_add_u32 s6, s6, s7
    s_lshl_b32 s6, s6, 1
    v_and_b32 v9, 1, v1
    v_lshlrev_b32 v9, 12, v9
    v_bfe_u32 v10, v1, 1, 1
    v_lshl_or_b32 v9, v10, 6, v9
    v_bfe_u32 v10, v1, 4, 1
    v_lshl_or_b32 v9, v10, 5, v9
    v_bfe_u32 v10, v1, 5, 1
    v_lshl_or_b32 v9, v10, 4, v9
    s_mov_b32 s52, s20
    s_mov_b32 s53, s21
    s_mov_b32 s54, 8192
    s_mov_b32 s55, 0x20000
    s_waitcnt vmcnt(0)
    s_mov_b32 s63, 2048
    s_mov_b32 s7, 32
    buffer_load_dwordx4 v[128:131], v8, s[48:51], s28 offen sc1
    buffer_load_dwordx4 v[132:135], v8, s[48:51], s29 offen sc1
    buffer_load_dwordx4 v[136:139], v8, s[48:51], s30 offen sc1
    buffer_load_dwordx4 v[140:143], v8, s[48:51], s31 offen sc1
L_h2:
    s_waitcnt vmcnt(0)
    v_pk_add_f32 v[160:161], v[128:129], v[136:137]
    v_pk_add_f32 v[162:163], v[130:131], v[138:139]
    v_pk_add_f32 v[164:165], v[132:133], v[140:141]
    v_pk_add_f32 v[166:167], v[134:135], v[142:143]
    v_pk_add_f32 v[160:161], v[160:161], v[164:165]
    v_pk_add_f32 v[162:163], v[162:163], v[166:167]
    v_cmp_u_f32 vcc, v160, v161
    v_cmp_u_f32 s[4:5], v162, v163
    s_or_b64 exec, vcc, s[4:5]
    s_cbranch_scc1 L_h2r
L_h2ok:
    s_mov_b64 exec, -1
    v_permlane32_swap_b32 v160, v161
    v_permlane32_swap_b32 v162, v163
    v_add_f32 v160, v160, v161
    v_add_f32 v162, v162, v163
    s_nop 1
    v_permlane16_swap_b32 v160, v162
    v_add_f32 v160, v160, v162
    s_nop 1
    v_add_f32_dpp v160, v160, v160 row_ror:4 row_mask:0xf bank_mask:0xf
    s_nop 1
    v_add_f32_dpp v160, v160, v160 row_ror:8 row_mask:0xf bank_mask:0xf
    v_cvt_pk_bf16_f32 v160, v160, v160
    s_mov_b32 exec_lo, 0x000f000f
    s_mov_b32 exec_hi, 0x000f000f
    buffer_store_short v160, v9, s[52:55], s6 offen sc1
L_end:
    s_endpgm
L_h2r:
    s_sub_u32 s7, s7, 1
    s_cbranch_scc0 L_h2i
    v_max3_u32 v12, v128, v129, v130
    v_max3_u32 v12, v12, v131, v132
    v_max3_u32 v12, v12, v133, v134
    v_max3_u32 v12, v12, v135, v136
    v_max3_u32 v12, v12, v137, v138
    v_max3_u32 v12, v12, v139, v140
    v_max3_u32 v12, v12, v141, v142
    v_max_u32 v12, v12, v143
    v_cmp_eq_u32 vcc, -1, v12
    s_and_b64 exec, exec, vcc
    s_cbranch_scc0 L_h2ok
    s_mov_b32 s7, 32
    s_sub_u32 s63, s63, 1
    s_cmp_eq_u32 s63, 0
    s_cbranch_scc1 L_h2ok
L_h2i:
    buffer_load_dwordx4 v[128:131], v8, s[48:51], s28 offen sc1
    buffer_load_dwordx4 v[132:135], v8, s[48:51], s29 offen sc1
    buffer_load_dwordx4 v[136:139], v8, s[48:51], s30 offen sc1
    buffer_load_dwordx4 v[140:143], v8, s[48:51], s31 offen sc1
    s_branch L_h2
L_h1r:
    s_sub_u32 s7, s7, 1
    s_cbranch_scc0 L_h1i
    v_max3_u32 v12, v32, v33, v34
    v_max3_u32 v12, v12, v35, v36
    v_max3_u32 v12, v12, v37, v38
    v_max3_u32 v12, v12, v39, v40
    v_max3_u32 v12, v12, v41, v42
    v_max3_u32 v12, v12, v43, v44
    v_max3_u32 v12, v12, v45, v46
    v_max_u32 v12, v12, v47
    v_cmp_eq_u32 vcc, -1, v12
    s_and_b64 exec, exec, vcc
    s_cbranch_scc0 L_h1ok
    s_mov_b32 s7, 32
    s_sub_u32 s63, s63, 1
    s_cmp_eq_u32 s63, 0
    s_cbranch_scc1 L_h1ok
L_h1i:
    buffer_load_dwordx4 v[32:35], v8, s[48:51], s8 offen sc1
    buffer_load_dwordx4 v[36:39], v8, s[48:51], s9 offen sc1
    buffer_load_dwordx4 v[40:43], v8, s[48:51], s10 offen sc1
    buffer_load_dwordx4 v[44:47], v8, s[48:51], s11 offen sc1
    s_branch L_h1
L_qpub:
    v_mul_u32_u24 v12, 576, v10
    v_bfe_u32 v11, v1, 3, 2
    v_lshl_add_u32 v12, v11, 5, v12
    v_lshrrev_b32 v11, 5, v1
    v_lshl_add_u32 v12, v11, 4, v12
    v_bfe_u32 v11, v1, 1, 2
    v_lshl_add_u32 v12, v11, 2, v12
    ds_read_b32 v24, v12 offset:0
    ds_read_b32 v25, v12 offset:144
    ds_read_b32 v26, v12 offset:288
    ds_read_b32 v27, v12 offset:432
    ds_read_b32 v28, v12 offset:1152
    ds_read_b32 v29, v12 offset:1296
    ds_read_b32 v30, v12 offset:1440
    ds_read_b32 v31, v12 offset:1584
    ds_read_b32 v32, v12 offset:2304
    ds_read_b32 v33, v12 offset:2448
    ds_read_b32 v34, v12 offset:2592
    ds_read_b32 v35, v12 offset:2736
    ds_read_b32 v36, v12 offset:3456
    ds_read_b32 v37, v12 offset:3600
    ds_read_b32 v38, v12 offset:3744
    ds_read_b32 v39, v12 offset:3888
    s_lshl_b32 s4, s3, 2
    s_add_u32 s4, s4, s59
    s_lshl_b32 s4, s4, 5
    s_add_u32 s4, s4, s27
    s_lshl_b32 s4, s4, 10
    s_waitcnt lgkmcnt(0)
    v_add_f32 v24, v24, v32
    v_add_f32 v25, v25, v33
    v_add_f32 v26, v26, v34
    v_add_f32 v27, v27, v35
    v_add_f32 v28, v28, v36
    v_add_f32 v29, v29, v37
    v_add_f32 v30, v30, v38
    v_add_f32 v31, v31, v39
    v_add_f32 v24, v24, v28
    v_add_f32 v25, v25, v29
    v_add_f32 v26, v26, v30
    v_add_f32 v27, v27, v31
    buffer_store_dwordx4 v[24:27], v3, s[48:51], s4 offen sc1
    v_mov_b32 v28, -1
    v_mov_b32 v29, -1
    v_mov_b32 v30, -1
    v_mov_b32 v31, -1
    buffer_store_dwordx4 v[28:31], v3, s[48:51], s73 offen offset:0 sc1
    buffer_store_dwordx4 v[28:31], v3, s[48:51], s73 offen offset:1024 sc1
    buffer_store_dwordx4 v[28:31], v3, s[48:51], s73 offen offset:2048 sc1
    buffer_store_dwordx4 v[28:31], v3, s[48:51], s73 offen offset:3072 sc1
    buffer_store_dwordx4 v[28:31], v3, s[48:51], s75 offen offset:0 sc1
    buffer_store_dwordx4 v[28:31], v3, s[48:51], s75 offen offset:1024 sc1
    buffer_store_dwordx4 v[28:31], v3, s[48:51], s75 offen offset:2048 sc1
    buffer_store_dwordx4 v[28:31], v3, s[48:51], s75 offen offset:3072 sc1
    buffer_store_dwordx4 v[28:31], v3, s[48:51], s74 offen offset:0 sc1
    buffer_store_dwordx4 v[28:31], v3, s[48:51], s74 offen offset:1024 sc1
    buffer_store_dwordx4 v[28:31], v3, s[48:51], s74 offen offset:2048 sc1
    buffer_store_dwordx4 v[28:31], v3, s[48:51], s74 offen offset:3072 sc1
    s_mov_b64 exec, 0xff
    buffer_store_dwordx4 v[28:31], v3, s[48:51], s76 offen sc1
    s_mov_b64 exec, -1
    s_waitcnt vmcnt(0)
    s_atomic_add s18, s[22:23], s19
    buffer_load_dwordx4 a[76:79], v2, s[28:31], s56 offen offset:2176 nt
    s_addk_i32 s56, 0x4000
    buffer_load_dwordx4 a[80:83], v2, s[28:31], s56 offen offset:0 nt
    buffer_load_dwordx4 a[84:87], v2, s[28:31], s56 offen offset:128 nt
    buffer_load_dwordx4 a[88:91], v2, s[28:31], s56 offen offset:2048 nt
    buffer_load_dwordx4 a[92:95], v2, s[28:31], s56 offen offset:2176 nt
    s_addk_i32 s56, 0x4000
    buffer_load_dwordx4 a[96:99], v2, s[28:31], s56 offen offset:0 nt
    buffer_load_dwordx4 a[100:103], v2, s[28:31], s56 offen offset:128 nt
    buffer_load_dwordx4 a[104:107], v2, s[28:31], s56 offen offset:2048 nt
    buffer_load_dwordx4 a[108:111], v2, s[28:31], s56 offen offset:2176 nt
    s_addk_i32 s56, 0x4000
    buffer_load_dwordx4 a[112:115], v2, s[28:31], s56 offen offset:0 nt
    s_waitcnt vmcnt(9)
    buffer_load_dwordx4 a[116:119], v2, s[28:31], s56 offen offset:128 nt
    s_waitcnt vmcnt(9)
    buffer_load_dwordx4 a[120:123], v2, s[28:31], s56 offen offset:2048 nt
    s_waitcnt vmcnt(9)
    buffer_load_dwordx4 a[124:127], v2, s[28:31], s56 offen offset:2176 nt
    s_addk_i32 s56, 0x4000
    s_waitcnt vmcnt(9)
    buffer_load_dwordx4 a[128:131], v2, s[28:31], s56 offen offset:0 nt
    s_waitcnt vmcnt(9)
    buffer_load_dwordx4 a[132:135], v2, s[28:31], s56 offen offset:128 nt
    s_waitcnt vmcnt(9)
    buffer_load_dwordx4 a[136:139], v2, s[28:31], s56 offen offset:2048 nt
    s_waitcnt vmcnt(9)
    buffer_load_dwordx4 a[140:143], v2, s[28:31], s56 offen offset:2176 nt
    s_addk_i32 s56, 0x4000
    s_waitcnt vmcnt(9)
    buffer_load_dwordx4 a[144:147], v2, s[28:31], s56 offen offset:0 nt
    s_waitcnt vmcnt(9)
    buffer_load_dwordx4 a[148:151], v2, s[28:31], s56 offen offset:128 nt
    s_waitcnt vmcnt(9)
    buffer_load_dwordx4 a[152:155], v2, s[28:31], s56 offen offset:2048 nt
    s_branch L_qpubdone
L_qslow:
    s_waitcnt vmcnt(5)
    buffer_load_dwordx4 v[204:207], v2, s[36:39], s56 offen offset:2176 nt
    s_addk_i32 s56, 0x4000
    s_waitcnt vmcnt(5)
    buffer_load_dwordx4 v[208:211], v2, s[36:39], s56 offen offset:0 nt
    s_waitcnt vmcnt(5)
    buffer_load_dwordx4 v[212:215], v2, s[36:39], s56 offen offset:128 nt
    s_waitcnt vmcnt(5)
    buffer_load_dwordx4 v[216:219], v2, s[36:39], s56 offen offset:2048 nt
    s_waitcnt vmcnt(5)
    buffer_load_dwordx4 v[220:223], v2, s[36:39], s56 offen offset:2176 nt
    s_addk_i32 s56, 0x4000
    s_waitcnt vmcnt(5)
    buffer_load_dwordx4 v[224:227], v2, s[36:39], s56 offen offset:0 nt
    s_waitcnt vmcnt(5)
    buffer_load_dwordx4 v[228:231], v2, s[36:39], s56 offen offset:128 nt
    s_waitcnt vmcnt(5)
    buffer_load_dwordx4 v[232:235], v2, s[36:39], s56 offen offset:2048 nt
    s_waitcnt vmcnt(5)
    buffer_load_dwordx4 v[236:239], v2, s[36:39], s56 offen offset:2176 nt
    s_addk_i32 s56, 0x4000
    s_waitcnt vmcnt(5)
    buffer_load_dwordx4 v[240:243], v2, s[36:39], s56 offen offset:0 nt
    s_waitcnt vmcnt(5)
    buffer_load_dwordx4 v[244:247], v2, s[36:39], s56 offen offset:128 nt
    s_waitcnt vmcnt(5)
    buffer_load_dwordx4 v[248:251], v2, s[36:39], s56 offen offset:2048 nt
    s_waitcnt vmcnt(5)
    buffer_load_dwordx4 v[252:255], v2, s[36:39], s56 offen offset:2176 nt
    s_addk_i32 s56, 0x4000
    s_mov_b32 s63, 65536
L_qspin:
    global_load_dword v12, v11, s[22:23] sc1
    s_waitcnt vmcnt(0)
    v_cmp_gt_u32 vcc, 32, v12
    s_cbranch_vccz L_qok
    s_sleep 2
    s_sub_u32 s63, s63, 1
    s_cmp_lg_u32 s63, 0
    s_cbranch_scc1 L_qspin
L_qok:
    buffer_load_dwordx4 v[64:67], v10, s[48:51], s58 offen offset:0 sc1
    buffer_load_dwordx4 v[68:71], v10, s[48:51], s58 offen offset:1024 sc1
    buffer_load_dwordx4 v[72:75], v10, s[48:51], s58 offen offset:2048 sc1
    buffer_load_dwordx4 v[76:79], v10, s[48:51], s58 offen offset:3072 sc1
    buffer_load_dwordx4 v[80:83], v10, s[48:51], s71 offen offset:0 sc1
    buffer_load_dwordx4 v[84:87], v10, s[48:51], s71 offen offset:1024 sc1
    buffer_load_dwordx4 v[88:91], v10, s[48:51], s71 offen offset:2048 sc1
    buffer_load_dwordx4 v[92:95], v10, s[48:51], s71 offen offset:3072 sc1
    s_waitcnt vmcnt(0)
    s_branch L_qjoin
L_mlslow:
    s_mov_b32 s63, 65536
L_mlspin:
    s_sleep 2
    global_load_dword v18, v19, s[22:23] sc1
    buffer_load_dwordx2 v[56:57], v9, s[48:51], s77 offen sc1
    s_waitcnt vmcnt(0)
    v_max_u32 v12, v56, v57
    v_cmp_gt_u32 s[64:65], 32, v18
    v_cmp_eq_u32 s[4:5], -1, v12
    s_or_b64 s[4:5], s[4:5], s[64:65]
    s_cbranch_scc0 L_mlok
    s_sub_u32 s63, s63, 1
    s_cmp_lg_u32 s63, 0
    s_cbranch_scc1 L_mlspin
    s_branch L_mlok
L_codeend:
.section .rodata,"a"
.p2align 6
.amdhsa_kernel concat_heads__gqa_block_cached__gqa_block_cached__decode_kernel
  .amdhsa_next_free_vgpr 512
  .amdhsa_next_free_sgpr 102
  .amdhsa_accum_offset 256
  .amdhsa_group_segment_fixed_size 0
  .amdhsa_kernarg_size 104
  .amdhsa_user_sgpr_count 2
  .amdhsa_user_sgpr_kernarg_segment_ptr 1
  .amdhsa_system_sgpr_workgroup_id_x 1
  .amdhsa_float_denorm_mode_32 3
.end_amdhsa_kernel
```
